```python
import torch

def _softmax(x, axis=-1):
    return torch.softmax(x, dim=axis)
def _gelu(x):
    return torch.nn.functional.gelu(x, approximate="tanh")
def _silu(x):
    return torch.nn.functional.silu(x)
def _sigmoid(x):
    return torch.sigmoid(x)
def _layernorm(x, axis=-1, eps=1e-5):
    m = x.mean(dim=axis, keepdim=True)
    v = x.var(dim=axis, keepdim=True, unbiased=False)
    return (x - m) / torch.sqrt(v + eps)
def _scatter_add(tgt, idx, src, axis=0):
    return tgt.clone().index_add_(axis, idx, src)
def _segment_sum(src, seg, n):
    out = torch.zeros((n,) + src.shape[1:], dtype=src.dtype)
    return out.index_add_(0, seg, src)
def _pad(x, pw):
    flat = tuple(v for pair in reversed(pw) for v in pair)
    return torch.nn.functional.pad(x, flat)

kernel_name = 'standalone__mha_softmax__near_ridge'

def setup_inputs():

    _w = (lambda a: (lambda t: t.to(torch.bfloat16) if t.is_floating_point() else t)(torch.as_tensor(a)))
    B, H, Sq, Sk, D = 8, 32, 192, 1024, 128
    return {
        "q": _w((lambda *s: torch.randn(*s, dtype=torch.bfloat16) * 0.8)(B, H, Sq, D)),
        "k": _w((lambda *s: torch.randn(*s, dtype=torch.bfloat16) * 0.8)(B, H, Sk, D)),
        "v": _w((lambda *s: torch.randn(*s, dtype=torch.bfloat16) * 0.05)(B, H, Sk, D)),
    }

def reference(q, k, v):
    scale = q.shape[-1] ** -0.5
    scores = torch.einsum("bhqd,bhkd->bhqk", q, k) * scale
    p = _softmax(scores, axis=-1)
    return torch.einsum("bhqk,bhkd->bhqd", p, v)
```

```asm
; @launch grid=(256,1,1) block=(256,1,1) lds=163840
.amdgcn_target "amdgcn-amd-amdhsa--gfx950"
.text
.globl standalone__mha_softmax__near_ridge_kernel
.p2align 12
.p2align 8
.type standalone__mha_softmax__near_ridge_kernel,@function
standalone__mha_softmax__near_ridge_kernel:
    s_cmp_ge_u32 s2, 256
    s_cbranch_scc1 L_end
    s_load_dwordx8 s[4:11], s[0:1], 0
    s_getpc_b64 s[34:35]
L_pc:
    v_lshlrev_b32 v180, 7, v0
    v_min_u32 v180, L_end-L_pc, v180
    v_mov_b32 v181, s35
    v_add_co_u32 v180, vcc, s34, v180
    v_lshrrev_b32 v172, 6, v0
    v_and_b32 v173, 63, v0
    v_addc_co_u32 v181, vcc, 0, v181, vcc
    global_load_dword v182, v[180:181], off
    v_readfirstlane_b32 s3, v172
    v_and_b32 v174, 3, v0
    v_bfe_u32 v175, v0, 2, 2
    v_lshrrev_b32 v176, 4, v173
    v_lshlrev_b32 v0, 4, v174
    v_lshl_add_u32 v0, v176, 6, v0
    v_lshl_add_u32 v195, v175, 8, v0
    v_lshl_add_u32 v0, v175, 12, v0
    v_lshl_add_u32 v0, v172, 8, v0
    s_lshl_b32 s39, s2, 18
    s_mul_i32 s38, s2, 49152
    s_mul_i32 s28, s3, 1056
    s_mul_i32 s29, s3, 15616
    s_mul_i32 s37, s3, 12288
    s_add_u32 s29, s29, 101376
    s_mov_b32 s14, 49152
    s_mov_b32 s15, 0x20000
    s_mov_b32 s18, 262144
    s_mov_b32 s19, 0x20000
    s_mov_b32 s22, 274432
    s_mov_b32 s23, 0x20000
    s_mov_b32 s26, 49152
    s_mov_b32 s27, 0x20000
    s_mov_b32 s32, 0
    s_mov_b32 s30, 12288
    s_add_u32 s93, s28, 33792
    s_add_u32 s92, s28, 101376
    s_mov_b32 s31, s93
    s_waitcnt lgkmcnt(0)
    s_add_u32 s16, s6, s39
    s_addc_u32 s17, s7, 0
    s_add_u32 s12, s4, s38
    s_addc_u32 s13, s5, 0
    s_add_u32 m0, s28, 0
    s_nop 0
    buffer_load_dwordx4 v0, s[16:19], s32 offen nt lds
    s_add_u32 s24, s10, s38
    s_addc_u32 s25, s11, 0
    s_add_u32 s20, s8, s39
    s_addc_u32 s21, s9, 0
    s_sub_u32 s20, s20, 12288
    s_subb_u32 s21, s21, 0
    v_accvgpr_write_b32 a85, v195
    v_mov_b32 v196, v173
    v_lshrrev_b32 v202, 4, v196
    v_and_b32 v203, 15, v196
    v_and_b32 v204, 1, v196
    v_bfe_u32 v205, v196, 1, 1
    v_bfe_u32 v206, v196, 2, 2
    v_lshlrev_b32 v197, 4, v196
    v_lshl_add_u32 v197, v202, 6, v197
    v_add_u32 v197, s29, v197
    v_mul_u32_u24 v198, 320, v202
    v_lshl_add_u32 v198, v204, 7, v198
    v_lshl_add_u32 v198, v206, 4, v198
    v_lshl_add_u32 v198, v205, 3, v198
    v_add_u32 v198, s29, v198
    v_lshl_add_u32 v200, v203, 2, s29
    v_lshl_add_u32 v201, v202, 4, s29
    v_and_b32 v204, 3, v196
    v_bfe_u32 v205, v196, 2, 1
    v_bfe_u32 v206, v196, 3, 1
    v_lshlrev_b32 v199, 10, v202
    v_lshl_add_u32 v199, v204, 5, v199
    v_lshl_add_u32 v199, v205, 4, v199
    v_lshl_add_u32 v199, v206, 7, v199
    v_accvgpr_write_b32 a80, v197
    v_accvgpr_write_b32 a81, v198
    v_accvgpr_write_b32 a82, v199
    v_accvgpr_write_b32 a83, v200
    v_accvgpr_write_b32 a84, v201
    v_mul_u32_u24 v1, 1056, v175
    v_lshl_add_u32 v1, v174, 6, v1
    s_add_u32 m0, s28, 3200
    s_nop 0
    buffer_load_dwordx4 v0, s[16:19], s32 offen offset:1024 nt lds
    v_lshl_add_u32 v1, v176, 4, v1
    v_mul_u32_u24 v2, 1056, v176
    v_lshl_add_u32 v2, v175, 6, v2
    v_lshl_add_u32 v2, v174, 3, v2
    v_add_u32 v2, 33792, v2
    v_add_u32 v3, s29, v1
    s_mov_b32 s44, 1024
    s_mov_b32 s45, 4224
    s_mov_b32 s46, 274432
    s_mov_b32 s47, s29
    s_mov_b32 s94, 0x1240
    s_mov_b32 s34, 0x3e0293ee
    s_mov_b32 s35, 0x3e0293ee
    s_mov_b32 s36, 0x53800000
    s_mov_b32 s33, 0x3f803f80
    v_mov_b32 v4, 0
    v_mov_b32 v5, 0
    v_mov_b32 v6, 0
    v_mov_b32 v7, 0
    v_mov_b32 v8, 0
    v_mov_b32 v9, 0
    v_mov_b32 v10, 0
    v_mov_b32 v11, 0
    v_mov_b32 v12, 0
    v_mov_b32 v13, 0
    v_mov_b32 v14, 0
    v_mov_b32 v15, 0
    v_mov_b32 v16, 0
    v_mov_b32 v17, 0
    v_mov_b32 v18, 0
    v_mov_b32 v19, 0
    v_mov_b32 v20, 0
    v_mov_b32 v21, 0
    v_mov_b32 v22, 0
    v_mov_b32 v23, 0
    v_mov_b32 v24, 0
    v_mov_b32 v25, 0
    v_mov_b32 v26, 0
    s_add_u32 m0, s28, 6400
    s_nop 0
    buffer_load_dwordx4 v0, s[16:19], s32 offen offset:2048 nt lds
    v_mov_b32 v27, 0
    v_mov_b32 v28, 0
    v_mov_b32 v29, 0
    v_mov_b32 v30, 0
    v_mov_b32 v31, 0
    v_mov_b32 v32, 0
    v_mov_b32 v33, 0
    v_mov_b32 v34, 0
    v_mov_b32 v35, 0
    v_mov_b32 v36, 0
    v_mov_b32 v37, 0
    v_mov_b32 v38, 0
    v_mov_b32 v39, 0
    v_mov_b32 v40, 0
    v_mov_b32 v41, 0
    v_mov_b32 v42, 0
    v_mov_b32 v43, 0
    v_mov_b32 v44, 0
    v_mov_b32 v45, 0
    v_mov_b32 v46, 0
    v_mov_b32 v47, 0
    v_mov_b32 v48, 0
    v_mov_b32 v49, 0
    v_mov_b32 v50, 0
    v_mov_b32 v51, 0
    v_mov_b32 v52, 0
    v_mov_b32 v53, 0
    v_mov_b32 v54, 0
    v_mov_b32 v55, 0
    v_mov_b32 v56, 0
    v_mov_b32 v57, 0
    v_mov_b32 v58, 0
    v_mov_b32 v59, 0
    v_mov_b32 v60, 0
    v_mov_b32 v61, 0
    v_mov_b32 v62, 0
    v_mov_b32 v63, 0
    v_mov_b32 v64, 0
    s_add_u32 m0, s28, 9600
    s_nop 0
    buffer_load_dwordx4 v0, s[16:19], s32 offen offset:3072 nt lds
    s_add_u32 s32, s32, 16384
    v_mov_b32 v65, 0
    v_mov_b32 v66, 0
    v_mov_b32 v67, 0
    v_mov_b32 v68, 0
    v_mov_b32 v69, 0
    v_mov_b32 v70, 0
    v_mov_b32 v71, 0
    v_mov_b32 v72, 0
    v_mov_b32 v73, 0
    v_mov_b32 v74, 0
    v_mov_b32 v75, 0
    v_mov_b32 v76, 0
    v_mov_b32 v77, 0
    v_mov_b32 v78, 0
    v_mov_b32 v79, 0
    v_mov_b32 v80, 0
    v_mov_b32 v81, 0
    v_mov_b32 v82, 0
    v_mov_b32 v83, 0
    v_mov_b32 v84, 0
    v_mov_b32 v85, 0
    v_mov_b32 v86, 0
    v_mov_b32 v87, 0
    v_mov_b32 v88, 0
    v_mov_b32 v89, 0
    v_mov_b32 v90, 0
    v_mov_b32 v91, 0
    v_mov_b32 v92, 0
    v_mov_b32 v93, 0
    v_mov_b32 v94, 0
    v_mov_b32 v95, 0
    v_mov_b32 v96, 0
    v_mov_b32 v97, 0
    v_mov_b32 v98, 0
    v_mov_b32 v99, 0
    v_accvgpr_write_b32 a64, s33
    v_accvgpr_write_b32 a65, s33
    v_accvgpr_write_b32 a66, s33
    s_add_u32 m0, s29, 0
    s_nop 0
    buffer_load_dwordx4 v195, s[12:15], s37 offen nt lds
    s_add_u32 s37, s37, 1024
    v_accvgpr_write_b32 a67, s33
    v_accvgpr_write_b32 a68, 0
    v_accvgpr_write_b32 a69, 0
    v_accvgpr_write_b32 a70, 0
    v_accvgpr_write_b32 a71, 0
    v_accvgpr_write_b32 a72, 0
    v_accvgpr_write_b32 a73, 0
    v_accvgpr_write_b32 a74, 0
    v_accvgpr_write_b32 a75, 0
    v_accvgpr_write_b32 a76, 0
    v_accvgpr_write_b32 a77, 0
    v_accvgpr_write_b32 a78, 0
    v_accvgpr_write_b32 a79, 0
    v_accvgpr_write_b32 a16, 0
    v_accvgpr_write_b32 a17, 0
    v_accvgpr_write_b32 a18, 0
    v_accvgpr_write_b32 a19, 0
    v_accvgpr_write_b32 a20, 0
    v_accvgpr_write_b32 a21, 0
    v_accvgpr_write_b32 a22, 0
    v_accvgpr_write_b32 a23, 0
    v_accvgpr_write_b32 a24, 0
    v_accvgpr_write_b32 a25, 0
    v_accvgpr_write_b32 a26, 0
    v_accvgpr_write_b32 a27, 0
    v_accvgpr_write_b32 a28, 0
    v_accvgpr_write_b32 a29, 0
    v_accvgpr_write_b32 a30, 0
    v_accvgpr_write_b32 a31, 0
    v_mov_b64 v[184:185], 0
    v_mov_b64 v[186:187], 0
    v_mov_b64 v[188:189], 0
    v_mov_b64 v[190:191], 0
    v_mov_b64 v[192:193], 0
    s_mov_b32 s33, 0xffff0000
    s_mov_b32 s99, -33792
    s_mov_b32 s48, 0x4558
    s_mov_b32 s49, 0x0
    s_add_u32 m0, s29, 1056
    s_nop 0
    buffer_load_dwordx4 v195, s[12:15], s37 offen nt lds
    s_add_u32 s37, s37, 1024
    s_waitcnt vmcnt(5)
    s_add_u32 m0, s29, 2112
    s_nop 0
    buffer_load_dwordx4 v195, s[12:15], s37 offen nt lds
    s_add_u32 s37, s37, 1024
    s_waitcnt vmcnt(5)
    s_add_u32 m0, s29, 3168
    s_nop 0
    buffer_load_dwordx4 v195, s[12:15], s37 offen nt lds
    s_add_u32 s37, s37, 1024
    s_waitcnt vmcnt(4)
    s_barrier
    s_add_u32 m0, s29, 4224
    s_nop 0
    buffer_load_dwordx4 v195, s[12:15], s37 offen nt lds
    s_add_u32 s37, s37, 1024
    ds_read_b128 a[88:91], v1 offset:0
    ds_read_b128 a[92:95], v1 offset:256
    ds_read_b128 a[96:99], v1 offset:512
    ds_read_b128 a[100:103], v1 offset:768
    ds_read_b128 a[104:107], v1 offset:4224
    ds_read_b128 a[108:111], v1 offset:4480
    ds_read_b128 a[112:115], v1 offset:4736
    ds_read_b128 a[116:119], v1 offset:4992
    ds_read_b128 a[120:123], v1 offset:8448
    ds_read_b128 a[124:127], v1 offset:8704
    ds_read_b128 a[128:131], v1 offset:8960
    ds_read_b128 a[132:135], v1 offset:9216
    s_waitcnt lgkmcnt(6)
    ds_read_b128 a[136:139], v1 offset:12672
    ds_read_b128 a[140:143], v1 offset:12928
    ds_read_b128 a[144:147], v1 offset:13184
    ds_read_b128 a[148:151], v1 offset:13440
    s_waitcnt vmcnt(5)
    s_add_u32 m0, s29, 5280
    s_nop 0
    buffer_load_dwordx4 v195, s[12:15], s37 offen nt lds
    s_add_u32 s37, s37, 1024
    s_waitcnt vmcnt(5)
    s_add_u32 m0, s29, 6336
    s_nop 0
    buffer_load_dwordx4 v195, s[12:15], s37 offen nt lds
    s_add_u32 s37, s37, 1024
    s_waitcnt vmcnt(5)
    s_add_u32 m0, s29, 7392
    s_nop 0
    buffer_load_dwordx4 v195, s[12:15], s37 offen nt lds
    s_add_u32 s37, s37, 1024
    s_waitcnt vmcnt(4)
    ds_read_b128 v[208:211], v3 offset:0
    ds_read_b128 v[212:215], v3 offset:256
    ds_read_b128 v[216:219], v3 offset:512
    ds_read_b128 v[220:223], v3 offset:768
    s_add_u32 m0, s29, 8448
    s_nop 0
    buffer_load_dwordx4 v195, s[12:15], s37 offen nt lds
    s_add_u32 s37, s37, 1024
    s_waitcnt lgkmcnt(3)
    v_lshlrev_b32 v172, 16, v208
    v_and_b32 v173, s33, v208
    v_lshlrev_b32 v174, 16, v209
    v_and_b32 v175, s33, v209
    v_lshlrev_b32 v176, 16, v210
    v_and_b32 v177, s33, v210
    v_lshlrev_b32 v178, 16, v211
    v_and_b32 v179, s33, v211
    v_pk_mul_f32 v[172:173], v[172:173], s[34:35]
    v_pk_mul_f32 v[174:175], v[174:175], s[34:35]
    v_pk_mul_f32 v[176:177], v[176:177], s[34:35]
    v_pk_mul_f32 v[178:179], v[178:179], s[34:35]
    v_cvt_pk_bf16_f32 v208, v172, v173
    v_cvt_pk_bf16_f32 v209, v174, v175
    v_cvt_pk_bf16_f32 v210, v176, v177
    v_cvt_pk_bf16_f32 v211, v178, v179
    s_waitcnt lgkmcnt(2)
    v_lshlrev_b32 v172, 16, v212
    v_and_b32 v173, s33, v212
    v_lshlrev_b32 v174, 16, v213
    v_and_b32 v175, s33, v213
    v_lshlrev_b32 v176, 16, v214
    v_and_b32 v177, s33, v214
    v_lshlrev_b32 v178, 16, v215
    v_and_b32 v179, s33, v215
    v_pk_mul_f32 v[172:173], v[172:173], s[34:35]
    v_pk_mul_f32 v[174:175], v[174:175], s[34:35]
    v_pk_mul_f32 v[176:177], v[176:177], s[34:35]
    v_pk_mul_f32 v[178:179], v[178:179], s[34:35]
    v_cvt_pk_bf16_f32 v212, v172, v173
    v_cvt_pk_bf16_f32 v213, v174, v175
    v_cvt_pk_bf16_f32 v214, v176, v177
    v_cvt_pk_bf16_f32 v215, v178, v179
    s_waitcnt lgkmcnt(1)
    v_lshlrev_b32 v172, 16, v216
    v_and_b32 v173, s33, v216
    v_lshlrev_b32 v174, 16, v217
    v_and_b32 v175, s33, v217
    v_lshlrev_b32 v176, 16, v218
    v_and_b32 v177, s33, v218
    v_lshlrev_b32 v178, 16, v219
    v_and_b32 v179, s33, v219
    v_pk_mul_f32 v[172:173], v[172:173], s[34:35]
    v_pk_mul_f32 v[174:175], v[174:175], s[34:35]
    v_pk_mul_f32 v[176:177], v[176:177], s[34:35]
    v_pk_mul_f32 v[178:179], v[178:179], s[34:35]
    v_cvt_pk_bf16_f32 v216, v172, v173
    v_cvt_pk_bf16_f32 v217, v174, v175
    v_cvt_pk_bf16_f32 v218, v176, v177
    v_cvt_pk_bf16_f32 v219, v178, v179
    s_add_u32 m0, s29, 9504
    s_nop 0
    buffer_load_dwordx4 v195, s[12:15], s37 offen nt lds
    s_add_u32 s37, s37, 1024
    s_waitcnt lgkmcnt(0)
    v_lshlrev_b32 v172, 16, v220
    v_and_b32 v173, s33, v220
    v_lshlrev_b32 v174, 16, v221
    v_and_b32 v175, s33, v221
    v_lshlrev_b32 v176, 16, v222
    v_and_b32 v177, s33, v222
    v_lshlrev_b32 v178, 16, v223
    v_and_b32 v179, s33, v223
    v_pk_mul_f32 v[172:173], v[172:173], s[34:35]
    v_pk_mul_f32 v[174:175], v[174:175], s[34:35]
    v_pk_mul_f32 v[176:177], v[176:177], s[34:35]
    v_pk_mul_f32 v[178:179], v[178:179], s[34:35]
    v_cvt_pk_bf16_f32 v220, v172, v173
    v_cvt_pk_bf16_f32 v221, v174, v175
    v_cvt_pk_bf16_f32 v222, v176, v177
    v_cvt_pk_bf16_f32 v223, v178, v179
    v_mfma_f32_16x16x32_bf16 v[100:103], a[88:91], v[208:211], 0
    v_mfma_f32_16x16x32_bf16 v[100:103], a[92:95], v[212:215], v[100:103]
    v_mfma_f32_16x16x32_bf16 v[100:103], a[96:99], v[216:219], v[100:103]
    v_mfma_f32_16x16x32_bf16 v[100:103], a[100:103], v[220:223], v[100:103]
    v_mfma_f32_16x16x32_bf16 v[112:115], a[104:107], v[208:211], 0
    v_mfma_f32_16x16x32_bf16 v[112:115], a[108:111], v[212:215], v[112:115]
    s_add_u32 m0, s29, 10560
    s_nop 0
    buffer_load_dwordx4 v195, s[12:15], s37 offen nt lds
    s_add_u32 s37, s37, 1024
    v_mfma_f32_16x16x32_bf16 v[112:115], a[112:115], v[216:219], v[112:115]
    v_mfma_f32_16x16x32_bf16 v[112:115], a[116:119], v[220:223], v[112:115]
    v_mfma_f32_16x16x32_bf16 v[124:127], a[120:123], v[208:211], 0
    v_max3_f32 v172, v100, v101, v102
    v_max_f32 v172, v172, v103
    v_mfma_f32_16x16x32_bf16 v[124:127], a[124:127], v[212:215], v[124:127]
    v_mov_b32 v173, v172
    s_nop 0
    v_mfma_f32_16x16x32_bf16 v[124:127], a[128:131], v[216:219], v[124:127]
    v_permlane16_swap_b32 v172, v173
    v_max_f32 v172, v172, v173
    v_mfma_f32_16x16x32_bf16 v[124:127], a[132:135], v[220:223], v[124:127]
    v_mov_b32 v173, v172
    s_nop 0
    v_mfma_f32_16x16x32_bf16 v[136:139], a[136:139], v[208:211], 0
    v_permlane32_swap_b32 v172, v173
    v_max_f32 v172, v172, v173
    v_mfma_f32_16x16x32_bf16 v[136:139], a[140:143], v[212:215], v[136:139]
    v_sub_f32 v100, v100, v172
    v_sub_f32 v101, v101, v172
    v_mfma_f32_16x16x32_bf16 v[136:139], a[144:147], v[216:219], v[136:139]
    v_sub_f32 v102, v102, v172
    v_sub_f32 v103, v103, v172
    v_mfma_f32_16x16x32_bf16 v[136:139], a[148:151], v[220:223], v[136:139]
    v_sub_f32 v112, v112, v172
    v_sub_f32 v113, v113, v172
    v_sub_f32 v114, v114, v172
    v_sub_f32 v115, v115, v172
    v_exp_f32 v100, v100
    v_exp_f32 v101, v101
    v_exp_f32 v102, v102
    v_exp_f32 v103, v103
    v_sub_f32 v124, v124, v172
    v_sub_f32 v125, v125, v172
    v_sub_f32 v126, v126, v172
    v_sub_f32 v127, v127, v172
    v_exp_f32 v112, v112
    v_exp_f32 v113, v113
    v_exp_f32 v114, v114
    v_exp_f32 v115, v115
    s_add_u32 m0, s29, 11616
    s_nop 0
    buffer_load_dwordx4 v195, s[12:15], s37 offen nt lds
    s_add_u32 s37, s37, 1024
    v_sub_f32 v136, v136, v172
    v_sub_f32 v137, v137, v172
    v_sub_f32 v138, v138, v172
    v_sub_f32 v139, v139, v172
    v_exp_f32 v124, v124
    v_exp_f32 v125, v125
    v_exp_f32 v126, v126
    v_exp_f32 v127, v127
    v_exp_f32 v136, v136
    v_sub_f32 v196, 0, v172
    v_sub_f32 v197, 0, v172
    v_sub_f32 v198, 0, v172
    v_sub_f32 v199, 0, v172
    v_cvt_pk_bf16_f32 v148, v100, v101
    v_cvt_pk_bf16_f32 v149, v102, v103
    s_waitcnt vmcnt(4)
    ds_read_b128 v[224:227], v3 offset:4224
    ds_read_b128 v[228:231], v3 offset:4480
    ds_read_b128 v[232:235], v3 offset:4736
    ds_read_b128 v[236:239], v3 offset:4992
    s_add_u32 m0, s28, 16896
    s_nop 0
    buffer_load_dwordx4 v0, s[16:19], s32 offen nt lds
    s_waitcnt lgkmcnt(3)
    v_lshlrev_b32 v172, 16, v224
    v_and_b32 v173, s33, v224
    v_lshlrev_b32 v174, 16, v225
    v_and_b32 v175, s33, v225
    v_lshlrev_b32 v176, 16, v226
    v_and_b32 v177, s33, v226
    v_lshlrev_b32 v178, 16, v227
    v_and_b32 v179, s33, v227
    v_pk_mul_f32 v[172:173], v[172:173], s[34:35]
    v_pk_mul_f32 v[174:175], v[174:175], s[34:35]
    v_pk_mul_f32 v[176:177], v[176:177], s[34:35]
    v_pk_mul_f32 v[178:179], v[178:179], s[34:35]
    v_cvt_pk_bf16_f32 v224, v172, v173
    v_cvt_pk_bf16_f32 v225, v174, v175
    v_cvt_pk_bf16_f32 v226, v176, v177
    v_cvt_pk_bf16_f32 v227, v178, v179
    s_waitcnt lgkmcnt(2)
    v_lshlrev_b32 v172, 16, v228
    v_and_b32 v173, s33, v228
    v_lshlrev_b32 v174, 16, v229
    v_and_b32 v175, s33, v229
    v_lshlrev_b32 v176, 16, v230
    v_and_b32 v177, s33, v230
    v_lshlrev_b32 v178, 16, v231
    v_and_b32 v179, s33, v231
    v_pk_mul_f32 v[172:173], v[172:173], s[34:35]
    v_pk_mul_f32 v[174:175], v[174:175], s[34:35]
    v_pk_mul_f32 v[176:177], v[176:177], s[34:35]
    v_pk_mul_f32 v[178:179], v[178:179], s[34:35]
    v_cvt_pk_bf16_f32 v228, v172, v173
    v_cvt_pk_bf16_f32 v229, v174, v175
    v_cvt_pk_bf16_f32 v230, v176, v177
    v_cvt_pk_bf16_f32 v231, v178, v179
    s_waitcnt lgkmcnt(1)
    v_lshlrev_b32 v172, 16, v232
    v_and_b32 v173, s33, v232
    v_lshlrev_b32 v174, 16, v233
    v_and_b32 v175, s33, v233
    v_lshlrev_b32 v176, 16, v234
    v_and_b32 v177, s33, v234
    v_lshlrev_b32 v178, 16, v235
    v_and_b32 v179, s33, v235
    v_pk_mul_f32 v[172:173], v[172:173], s[34:35]
    v_pk_mul_f32 v[174:175], v[174:175], s[34:35]
    v_pk_mul_f32 v[176:177], v[176:177], s[34:35]
    v_pk_mul_f32 v[178:179], v[178:179], s[34:35]
    v_cvt_pk_bf16_f32 v232, v172, v173
    v_cvt_pk_bf16_f32 v233, v174, v175
    v_cvt_pk_bf16_f32 v234, v176, v177
    v_cvt_pk_bf16_f32 v235, v178, v179
    s_add_u32 m0, s28, 20096
    s_nop 0
    buffer_load_dwordx4 v0, s[16:19], s32 offen offset:1024 nt lds
    s_waitcnt lgkmcnt(0)
    v_lshlrev_b32 v172, 16, v236
    v_and_b32 v173, s33, v236
    v_lshlrev_b32 v174, 16, v237
    v_and_b32 v175, s33, v237
    v_lshlrev_b32 v176, 16, v238
    v_and_b32 v177, s33, v238
    v_lshlrev_b32 v178, 16, v239
    v_and_b32 v179, s33, v239
    v_pk_mul_f32 v[172:173], v[172:173], s[34:35]
    v_pk_mul_f32 v[174:175], v[174:175], s[34:35]
    v_pk_mul_f32 v[176:177], v[176:177], s[34:35]
    v_pk_mul_f32 v[178:179], v[178:179], s[34:35]
    v_cvt_pk_bf16_f32 v236, v172, v173
    v_cvt_pk_bf16_f32 v237, v174, v175
    v_cvt_pk_bf16_f32 v238, v176, v177
    v_cvt_pk_bf16_f32 v239, v178, v179
    v_mfma_f32_16x16x32_bf16 v[104:107], a[88:91], v[224:227], 0
    v_mfma_f32_16x16x32_bf16 v[104:107], a[92:95], v[228:231], v[104:107]
    v_mfma_f32_16x16x32_bf16 v[104:107], a[96:99], v[232:235], v[104:107]
    v_mfma_f32_16x16x32_bf16 v[104:107], a[100:103], v[236:239], v[104:107]
    v_mfma_f32_16x16x32_bf16 v[116:119], a[104:107], v[224:227], 0
    v_mfma_f32_16x16x32_bf16 v[116:119], a[108:111], v[228:231], v[116:119]
    s_add_u32 m0, s28, 23296
    s_nop 0
    buffer_load_dwordx4 v0, s[16:19], s32 offen offset:2048 nt lds
    v_mfma_f32_16x16x32_bf16 v[116:119], a[112:115], v[232:235], v[116:119]
    v_mfma_f32_16x16x32_bf16 v[116:119], a[116:119], v[236:239], v[116:119]
    v_mfma_f32_16x16x32_bf16 v[128:131], a[120:123], v[224:227], 0
    v_max3_f32 v172, v104, v105, v106
    v_max_f32 v172, v172, v107
    v_mfma_f32_16x16x32_bf16 v[128:131], a[124:127], v[228:231], v[128:131]
    v_mov_b32 v173, v172
    s_nop 0
    v_mfma_f32_16x16x32_bf16 v[128:131], a[128:131], v[232:235], v[128:131]
    v_permlane16_swap_b32 v172, v173
    v_max_f32 v172, v172, v173
    v_mfma_f32_16x16x32_bf16 v[128:131], a[132:135], v[236:239], v[128:131]
    v_mov_b32 v173, v172
    s_nop 0
    v_mfma_f32_16x16x32_bf16 v[140:143], a[136:139], v[224:227], 0
    v_permlane32_swap_b32 v172, v173
    v_max_f32 v172, v172, v173
    v_mfma_f32_16x16x32_bf16 v[140:143], a[140:143], v[228:231], v[140:143]
    v_sub_f32 v104, v104, v172
    v_sub_f32 v105, v105, v172
    v_mfma_f32_16x16x32_bf16 v[140:143], a[144:147], v[232:235], v[140:143]
    v_sub_f32 v106, v106, v172
    v_sub_f32 v107, v107, v172
    v_mfma_f32_16x16x32_bf16 v[140:143], a[148:151], v[236:239], v[140:143]
    v_sub_f32 v116, v116, v172
    v_sub_f32 v117, v117, v172
    v_sub_f32 v118, v118, v172
    v_sub_f32 v119, v119, v172
    v_exp_f32 v104, v104
    v_exp_f32 v105, v105
    v_exp_f32 v106, v106
    v_exp_f32 v107, v107
    v_sub_f32 v128, v128, v172
    v_sub_f32 v129, v129, v172
    v_sub_f32 v130, v130, v172
    v_sub_f32 v131, v131, v172
    v_exp_f32 v116, v116
    v_exp_f32 v117, v117
    v_exp_f32 v118, v118
    v_exp_f32 v119, v119
    s_add_u32 m0, s28, 26496
    s_nop 0
    buffer_load_dwordx4 v0, s[16:19], s32 offen offset:3072 nt lds
    s_add_u32 s32, s32, 16384
    v_sub_f32 v140, v140, v172
    v_sub_f32 v141, v141, v172
    v_sub_f32 v142, v142, v172
    v_sub_f32 v143, v143, v172
    v_exp_f32 v128, v128
    v_exp_f32 v129, v129
    v_exp_f32 v130, v130
    v_exp_f32 v131, v131
    v_exp_f32 v140, v140
    v_exp_f32 v141, v141
    v_exp_f32 v142, v142
    v_exp_f32 v143, v143
    v_sub_f32 v200, 0, v172
    v_sub_f32 v201, 0, v172
    v_sub_f32 v202, 0, v172
    v_sub_f32 v203, 0, v172
    v_cvt_pk_bf16_f32 v156, v104, v105
    v_cvt_pk_bf16_f32 v157, v106, v107
    s_waitcnt vmcnt(4)
    ds_read_b128 v[240:243], v3 offset:8448
    ds_read_b128 v[244:247], v3 offset:8704
    ds_read_b128 v[248:251], v3 offset:8960
    ds_read_b128 v[252:255], v3 offset:9216
    s_mov_b32 m0, s31
    s_nop 0
    buffer_load_dwordx4 v0, s[20:23], s30 offen nt lds
    s_add_u32 s30, s30, 1024
    s_add_u32 s31, s31, 4224
    s_or_b32 s30, s30, 0x3000
    s_cmp_eq_u32 s31, s92
    s_cselect_b32 s31, s93, s31
    s_waitcnt lgkmcnt(3)
    v_lshlrev_b32 v172, 16, v240
    v_and_b32 v173, s33, v240
    v_lshlrev_b32 v174, 16, v241
    v_and_b32 v175, s33, v241
    v_lshlrev_b32 v176, 16, v242
    v_and_b32 v177, s33, v242
    v_lshlrev_b32 v178, 16, v243
    v_and_b32 v179, s33, v243
    v_pk_mul_f32 v[172:173], v[172:173], s[34:35]
    v_pk_mul_f32 v[174:175], v[174:175], s[34:35]
    v_pk_mul_f32 v[176:177], v[176:177], s[34:35]
    v_pk_mul_f32 v[178:179], v[178:179], s[34:35]
    v_cvt_pk_bf16_f32 v240, v172, v173
    v_cvt_pk_bf16_f32 v241, v174, v175
    v_cvt_pk_bf16_f32 v242, v176, v177
    v_cvt_pk_bf16_f32 v243, v178, v179
    s_waitcnt lgkmcnt(2)
    v_lshlrev_b32 v172, 16, v244
    v_and_b32 v173, s33, v244
    v_lshlrev_b32 v174, 16, v245
    v_and_b32 v175, s33, v245
    v_lshlrev_b32 v176, 16, v246
    v_and_b32 v177, s33, v246
    v_lshlrev_b32 v178, 16, v247
    v_and_b32 v179, s33, v247
    v_pk_mul_f32 v[172:173], v[172:173], s[34:35]
    v_pk_mul_f32 v[174:175], v[174:175], s[34:35]
    v_pk_mul_f32 v[176:177], v[176:177], s[34:35]
    v_pk_mul_f32 v[178:179], v[178:179], s[34:35]
    v_cvt_pk_bf16_f32 v244, v172, v173
    v_cvt_pk_bf16_f32 v245, v174, v175
    v_cvt_pk_bf16_f32 v246, v176, v177
    v_cvt_pk_bf16_f32 v247, v178, v179
    s_waitcnt lgkmcnt(1)
    v_lshlrev_b32 v172, 16, v248
    v_and_b32 v173, s33, v248
    v_lshlrev_b32 v174, 16, v249
    v_and_b32 v175, s33, v249
    v_lshlrev_b32 v176, 16, v250
    v_and_b32 v177, s33, v250
    v_lshlrev_b32 v178, 16, v251
    v_and_b32 v179, s33, v251
    v_pk_mul_f32 v[172:173], v[172:173], s[34:35]
    v_pk_mul_f32 v[174:175], v[174:175], s[34:35]
    v_pk_mul_f32 v[176:177], v[176:177], s[34:35]
    v_pk_mul_f32 v[178:179], v[178:179], s[34:35]
    v_cvt_pk_bf16_f32 v248, v172, v173
    v_cvt_pk_bf16_f32 v249, v174, v175
    v_cvt_pk_bf16_f32 v250, v176, v177
    v_cvt_pk_bf16_f32 v251, v178, v179
    s_mov_b32 m0, s31
    s_nop 0
    buffer_load_dwordx4 v0, s[20:23], s30 offen nt lds
    s_add_u32 s30, s30, 1024
    s_add_u32 s31, s31, 4224
    s_or_b32 s30, s30, 0x3000
    s_cmp_eq_u32 s31, s92
    s_cselect_b32 s31, s93, s31
    s_waitcnt lgkmcnt(0)
    v_lshlrev_b32 v172, 16, v252
    v_and_b32 v173, s33, v252
    v_lshlrev_b32 v174, 16, v253
    v_and_b32 v175, s33, v253
    v_lshlrev_b32 v176, 16, v254
    v_and_b32 v177, s33, v254
    v_lshlrev_b32 v178, 16, v255
    v_and_b32 v179, s33, v255
    v_pk_mul_f32 v[172:173], v[172:173], s[34:35]
    v_pk_mul_f32 v[174:175], v[174:175], s[34:35]
    v_pk_mul_f32 v[176:177], v[176:177], s[34:35]
    v_pk_mul_f32 v[178:179], v[178:179], s[34:35]
    v_cvt_pk_bf16_f32 v252, v172, v173
    v_cvt_pk_bf16_f32 v253, v174, v175
    v_cvt_pk_bf16_f32 v254, v176, v177
    v_cvt_pk_bf16_f32 v255, v178, v179
    v_mfma_f32_16x16x32_bf16 v[108:111], a[88:91], v[240:243], 0
    v_mfma_f32_16x16x32_bf16 v[108:111], a[92:95], v[244:247], v[108:111]
    v_mfma_f32_16x16x32_bf16 v[108:111], a[96:99], v[248:251], v[108:111]
    v_mfma_f32_16x16x32_bf16 v[108:111], a[100:103], v[252:255], v[108:111]
    v_mfma_f32_16x16x32_bf16 v[120:123], a[104:107], v[240:243], 0
    v_mfma_f32_16x16x32_bf16 v[120:123], a[108:111], v[244:247], v[120:123]
    s_mov_b32 m0, s31
    s_nop 0
    buffer_load_dwordx4 v0, s[20:23], s30 offen nt lds
    s_add_u32 s30, s30, 1024
    s_add_u32 s31, s31, 4224
    s_or_b32 s30, s30, 0x3000
    s_cmp_eq_u32 s31, s92
    s_cselect_b32 s31, s93, s31
    v_mfma_f32_16x16x32_bf16 v[120:123], a[112:115], v[248:251], v[120:123]
    v_mfma_f32_16x16x32_bf16 v[120:123], a[116:119], v[252:255], v[120:123]
    v_mfma_f32_16x16x32_bf16 v[132:135], a[120:123], v[240:243], 0
    v_max3_f32 v172, v108, v109, v110
    v_max_f32 v172, v172, v111
    v_mfma_f32_16x16x32_bf16 v[132:135], a[124:127], v[244:247], v[132:135]
    v_mov_b32 v173, v172
    s_nop 0
    v_mfma_f32_16x16x32_bf16 v[132:135], a[128:131], v[248:251], v[132:135]
    v_permlane16_swap_b32 v172, v173
    v_max_f32 v172, v172, v173
    v_mfma_f32_16x16x32_bf16 v[132:135], a[132:135], v[252:255], v[132:135]
    v_mov_b32 v173, v172
    s_nop 0
    v_mfma_f32_16x16x32_bf16 v[144:147], a[136:139], v[240:243], 0
    v_permlane32_swap_b32 v172, v173
    v_max_f32 v172, v172, v173
    v_mfma_f32_16x16x32_bf16 v[144:147], a[140:143], v[244:247], v[144:147]
    v_sub_f32 v108, v108, v172
    v_sub_f32 v109, v109, v172
    v_mfma_f32_16x16x32_bf16 v[144:147], a[144:147], v[248:251], v[144:147]
    v_sub_f32 v110, v110, v172
    v_sub_f32 v111, v111, v172
    v_mfma_f32_16x16x32_bf16 v[144:147], a[148:151], v[252:255], v[144:147]
    v_sub_f32 v120, v120, v172
    v_sub_f32 v121, v121, v172
    v_sub_f32 v122, v122, v172
    v_sub_f32 v123, v123, v172
    v_exp_f32 v108, v108
    v_exp_f32 v109, v109
    v_exp_f32 v110, v110
    v_exp_f32 v111, v111
    v_sub_f32 v132, v132, v172
    v_sub_f32 v133, v133, v172
    v_sub_f32 v134, v134, v172
    v_sub_f32 v135, v135, v172
    v_exp_f32 v120, v120
    v_exp_f32 v121, v121
    v_exp_f32 v122, v122
    v_exp_f32 v123, v123
    s_mov_b32 m0, s31
    s_nop 0
    buffer_load_dwordx4 v0, s[20:23], s30 offen nt lds
    s_add_u32 s30, s30, 1024
    s_add_u32 s31, s31, 4224
    s_or_b32 s30, s30, 0x3000
    s_cmp_eq_u32 s31, s92
    s_cselect_b32 s31, s93, s31
    v_sub_f32 v144, v144, v172
    v_sub_f32 v145, v145, v172
    v_sub_f32 v146, v146, v172
    v_sub_f32 v147, v147, v172
    v_exp_f32 v132, v132
    v_exp_f32 v133, v133
    v_exp_f32 v134, v134
    v_exp_f32 v135, v135
    v_exp_f32 v144, v144
    v_exp_f32 v145, v145
    v_exp_f32 v146, v146
    v_exp_f32 v147, v147
    v_sub_f32 v204, 0, v172
    v_sub_f32 v205, 0, v172
    v_sub_f32 v206, 0, v172
    v_sub_f32 v207, 0, v172
    v_cvt_pk_bf16_f32 v164, v108, v109
    v_cvt_pk_bf16_f32 v165, v110, v111
    v_mov_b64 v[172:173], 0
    v_mov_b64 v[174:175], 0
    v_mov_b64 v[176:177], 0
    v_mov_b64 v[178:179], 0
    v_mov_b64 v[180:181], 0
    v_mov_b64 v[182:183], 0
    v_mov_b64 v[194:195], 0
    s_waitcnt vmcnt(4)
    s_barrier
    s_branch L_entry
.p2align 12
L_gate0:
    s_and_b32 s33, s48, 3
    s_cbranch_scc0 L_done0
L_more0:
    s_mov_b32 m0, s31
    s_sub_u32 s33, s33, 1
    buffer_load_dwordx4 v0, s[20:23], s30 offen nt lds
    s_add_u32 s30, s30, 1024
    s_add_u32 s31, s31, 4224
    s_or_b32 s30, s30, 0x3000
    s_cmp_eq_u32 s31, s92
    s_cselect_b32 s31, s93, s31
    s_cmp_lg_u32 s33, 0
    s_cbranch_scc1 L_more0
L_done0:
    s_branch L_back0
L_gate1:
    s_and_b32 s33, s48, 3
    s_cbranch_scc0 L_done1
L_more1:
    s_mov_b32 m0, s31
    s_sub_u32 s33, s33, 1
    buffer_load_dwordx4 v0, s[20:23], s30 offen nt lds
    s_add_u32 s30, s30, 1024
    s_add_u32 s31, s31, 4224
    s_or_b32 s30, s30, 0x3000
    s_cmp_eq_u32 s31, s92
    s_cselect_b32 s31, s93, s31
    s_cmp_lg_u32 s33, 0
    s_cbranch_scc1 L_more1
L_done1:
    s_waitcnt vmcnt(4)
    s_barrier
    s_branch L_back1
L_gate2:
    s_and_b32 s33, s48, 3
    s_cbranch_scc0 L_done2
L_more2:
    s_mov_b32 m0, s31
    s_sub_u32 s33, s33, 1
    buffer_load_dwordx4 v0, s[20:23], s30 offen nt lds
    s_add_u32 s30, s30, 1024
    s_add_u32 s31, s31, 4224
    s_or_b32 s30, s30, 0x3000
    s_cmp_eq_u32 s31, s92
    s_cselect_b32 s31, s93, s31
    s_cmp_lg_u32 s33, 0
    s_cbranch_scc1 L_more2
L_done2:
    s_branch L_back2
L_gate3:
    s_and_b32 s33, s48, 3
    s_cbranch_scc0 L_done3
L_more3:
    s_mov_b32 m0, s31
    s_sub_u32 s33, s33, 1
    buffer_load_dwordx4 v0, s[20:23], s30 offen nt lds
    s_add_u32 s30, s30, 1024
    s_add_u32 s31, s31, 4224
    s_or_b32 s30, s30, 0x3000
    s_cmp_eq_u32 s31, s92
    s_cselect_b32 s31, s93, s31
    s_cmp_lg_u32 s33, 0
    s_cbranch_scc1 L_more3
L_done3:
    s_waitcnt vmcnt(4)
    s_barrier
    s_branch L_back3
.p2align 6
L_loop:
    v_mfma_f32_16x16x32_bf16 v[56:59], v[180:183], a[8:11], v[56:59]
    s_lshr_b64 s[48:49], s[48:49], 2
    v_exp_f32 v143, v143
    v_mfma_f32_16x16x32_bf16 v[56:59], v[184:187], a[12:15], v[56:59]
    s_cbranch_scc1 L_gate0
L_back0:
    v_add_u32 v2, s99, v2
    v_mfma_f32_16x16x32_bf16 v[24:27], v[176:179], a[12:15], v[24:27]
    s_waitcnt vmcnt(4) lgkmcnt(0)
    v_exp_f32 v136, v136
    v_mfma_f32_16x16x32_bf16 v[24:27], v[172:175], a[8:11], v[24:27]
    s_barrier
L_entry:
    v_mfma_f32_16x16x32_bf16 v[28:31], v[172:175], a[16:19], v[28:31]
    s_add_u32 m0, s28, 0
    ds_read_b128 a[0:3], v1 offset:16896
    v_cvt_pk_bf16_f32 v166, v120, v121
    v_mfma_f32_16x16x32_bf16 v[28:31], v[176:179], a[20:23], v[28:31]
    buffer_load_dwordx4 v0, s[16:19], s32 offen nt lds
    v_mfma_f32_16x16x32_bf16 v[60:63], v[184:187], a[20:23], v[60:63]
    ds_read_b128 a[4:7], v1 offset:17152
    v_cvt_pk_bf16_f32 v167, v122, v123
    v_mfma_f32_16x16x32_bf16 v[60:63], v[180:183], a[16:19], v[60:63]
    v_exp_f32 v137, v137
    v_mfma_f32_16x16x32_bf16 v[92:95], v[188:191], a[16:19], v[92:95]
    ds_read_b128 a[8:11], v1 offset:17408
    v_cvt_pk_bf16_f32 v158, v116, v117
    v_mfma_f32_16x16x32_bf16 v[92:95], v[192:195], a[20:23], v[92:95]
    v_exp_f32 v138, v138
    v_mfma_f32_16x16x32_bf16 v[96:99], v[192:195], a[28:31], v[96:99]
    ds_read_b128 a[12:15], v1 offset:17664
    v_cvt_pk_bf16_f32 v159, v118, v119
    v_mfma_f32_16x16x32_bf16 v[96:99], v[188:191], a[24:27], v[96:99]
    v_exp_f32 v139, v139
    v_mfma_f32_16x16x32_bf16 v[64:67], v[180:183], a[24:27], v[64:67]
    v_cvt_pk_bf16_f32 v150, v112, v113
    v_cvt_pk_bf16_f32 v151, v114, v115
    v_mfma_f32_16x16x32_bf16 v[64:67], v[184:187], a[28:31], v[64:67]
    v_cvt_pk_bf16_f32 v152, v124, v125
    v_cvt_pk_bf16_f32 v153, v126, v127
    v_mfma_f32_16x16x32_bf16 v[32:35], v[176:179], a[28:31], v[32:35]
    v_cvt_pk_bf16_f32 v160, v128, v129
    v_cvt_pk_bf16_f32 v161, v130, v131
    v_mfma_f32_16x16x32_bf16 v[32:35], v[172:175], a[24:27], v[32:35]
    s_waitcnt lgkmcnt(2)
    v_cvt_pk_bf16_f32 v168, v132, v133
    v_cvt_pk_bf16_f32 v169, v134, v135
    v_mfma_f32_16x16x32_bf16 v[100:103], a[0:3], v[208:211], v[196:199]
    s_add_u32 m0, s28, 3200
    ds_read_b128 a[28:31], v1 offset:21888
    v_cvt_pk_bf16_f32 v170, v144, v145
    v_mfma_f32_16x16x32_bf16 v[100:103], a[4:7], v[212:215], v[100:103]
    s_waitcnt lgkmcnt(1)
    buffer_load_dwordx4 v0, s[16:19], s32 offen offset:1024 nt lds
    v_mfma_f32_16x16x32_bf16 v[100:103], a[8:11], v[216:219], v[100:103]
    ds_read_b128 a[24:27], v1 offset:21632
    v_cvt_pk_bf16_f32 v171, v146, v147
    v_mfma_f32_16x16x32_bf16 v[100:103], a[12:15], v[220:223], v[100:103]
    v_cvt_pk_bf16_f32 v162, v140, v141
    v_cvt_pk_bf16_f32 v163, v142, v143
    v_mfma_f32_16x16x32_bf16 v[104:107], a[12:15], v[236:239], v[200:203]
    ds_read_b128 a[20:23], v1 offset:21376
    v_cvt_pk_bf16_f32 v154, v136, v137
    v_mfma_f32_16x16x32_bf16 v[104:107], a[8:11], v[232:235], v[104:107]
    v_cvt_pk_bf16_f32 v155, v138, v139
    v_mfma_f32_16x16x32_bf16 v[104:107], a[4:7], v[228:231], v[104:107]
    ds_read_b128 a[16:19], v1 offset:21120
    v_mfma_f32_16x16x32_bf16 v[104:107], a[0:3], v[224:227], v[104:107]
    v_mfma_f32_16x16x32_bf16 v[108:111], a[0:3], v[240:243], v[204:207]
    v_mfma_f32_16x16x32_bf16 v[108:111], a[4:7], v[244:247], v[108:111]
    v_mfma_f32_16x16x32_bf16 v[108:111], a[8:11], v[248:251], v[108:111]
    v_mfma_f32_16x16x32_bf16 v[108:111], a[12:15], v[252:255], v[108:111]
    s_waitcnt lgkmcnt(2)
    v_exp_f32 v100, v100
    v_mfma_f32_16x16x32_bf16 v[120:123], a[28:31], v[252:255], v[204:207]
    s_add_u32 m0, s28, 6400
    ds_read_b128 a[0:3], v1 offset:25344
    v_mfma_f32_16x16x32_bf16 v[120:123], a[24:27], v[248:251], v[120:123]
    s_waitcnt lgkmcnt(1)
    buffer_load_dwordx4 v0, s[16:19], s32 offen offset:2048 nt lds
    v_mfma_f32_16x16x32_bf16 v[120:123], a[20:23], v[244:247], v[120:123]
    ds_read_b128 a[4:7], v1 offset:25600
    v_mfma_f32_16x16x32_bf16 v[120:123], a[16:19], v[240:243], v[120:123]
    v_exp_f32 v101, v101
    v_mfma_f32_16x16x32_bf16 v[116:119], a[16:19], v[224:227], v[200:203]
    ds_read_b128 a[8:11], v1 offset:25856
    v_cvt_pk_bf16_f32 v172, v100, v101
    v_mfma_f32_16x16x32_bf16 v[116:119], a[20:23], v[228:231], v[116:119]
    v_exp_f32 v102, v102
    v_mfma_f32_16x16x32_bf16 v[116:119], a[24:27], v[232:235], v[116:119]
    ds_read_b128 a[12:15], v1 offset:26112
    v_mfma_f32_16x16x32_bf16 v[116:119], a[28:31], v[236:239], v[116:119]
    v_exp_f32 v103, v103
    v_mfma_f32_16x16x32_bf16 v[112:115], a[28:31], v[220:223], v[196:199]
    v_exp_f32 v104, v104
    v_mfma_f32_16x16x32_bf16 v[112:115], a[24:27], v[216:219], v[112:115]
    v_exp_f32 v105, v105
    v_mfma_f32_16x16x32_bf16 v[112:115], a[20:23], v[212:215], v[112:115]
    v_exp_f32 v106, v106
    v_mfma_f32_16x16x32_bf16 v[112:115], a[16:19], v[208:211], v[112:115]
    s_waitcnt lgkmcnt(2)
    v_exp_f32 v107, v107
    v_mfma_f32_16x16x32_bf16 v[124:127], a[0:3], v[208:211], v[196:199]
    s_add_u32 m0, s28, 9600
    ds_read_b128 a[28:31], v1 offset:30336
    v_cvt_pk_bf16_f32 v173, v102, v103
    v_mfma_f32_16x16x32_bf16 v[124:127], a[4:7], v[212:215], v[124:127]
    s_waitcnt lgkmcnt(1)
    buffer_load_dwordx4 v0, s[16:19], s32 offen offset:3072 nt lds
    v_mfma_f32_16x16x32_bf16 v[124:127], a[8:11], v[216:219], v[124:127]
    s_add_u32 s32, s32, 16384
    ds_read_b128 a[24:27], v1 offset:30080
    v_cvt_pk_bf16_f32 v180, v104, v105
    v_mfma_f32_16x16x32_bf16 v[124:127], a[12:15], v[220:223], v[124:127]
    v_exp_f32 v108, v108
    v_mfma_f32_16x16x32_bf16 v[128:131], a[12:15], v[236:239], v[200:203]
    ds_read_b128 a[20:23], v1 offset:29824
    v_cvt_pk_bf16_f32 v181, v106, v107
    v_mfma_f32_16x16x32_bf16 v[128:131], a[8:11], v[232:235], v[128:131]
    v_exp_f32 v109, v109
    v_mfma_f32_16x16x32_bf16 v[128:131], a[4:7], v[228:231], v[128:131]
    ds_read_b128 a[16:19], v1 offset:29568
    v_cvt_pk_bf16_f32 v188, v108, v109
    v_mfma_f32_16x16x32_bf16 v[128:131], a[0:3], v[224:227], v[128:131]
    v_exp_f32 v110, v110
    v_mfma_f32_16x16x32_bf16 v[132:135], a[0:3], v[240:243], v[204:207]
    v_exp_f32 v111, v111
    v_mfma_f32_16x16x32_bf16 v[132:135], a[4:7], v[244:247], v[132:135]
    s_lshr_b64 s[48:49], s[48:49], 2
    v_exp_f32 v120, v120
    v_mfma_f32_16x16x32_bf16 v[132:135], a[8:11], v[248:251], v[132:135]
    s_cbranch_scc1 L_gate1
L_back1:
    v_cvt_pk_bf16_f32 v189, v110, v111
    v_mfma_f32_16x16x32_bf16 v[132:135], a[12:15], v[252:255], v[132:135]
    s_waitcnt vmcnt(4) lgkmcnt(2)
    v_exp_f32 v121, v121
    v_mfma_f32_16x16x32_bf16 v[144:147], a[28:31], v[252:255], v[204:207]
    s_mov_b32 m0, s31
    ds_read_b64_tr_b16 a[0:1], v2 offset:0
    ds_read_b64_tr_b16 a[2:3], v2 offset:4224
    v_mfma_f32_16x16x32_bf16 v[144:147], a[24:27], v[248:251], v[144:147]
    s_waitcnt lgkmcnt(2)
    buffer_load_dwordx4 v0, s[20:23], s30 offen nt lds
    v_mfma_f32_16x16x32_bf16 v[144:147], a[20:23], v[244:247], v[144:147]
    s_add_u32 s30, s30, 1024
    ds_read_b64_tr_b16 a[4:5], v2 offset:8448
    ds_read_b64_tr_b16 a[6:7], v2 offset:12672
    v_mfma_f32_16x16x32_bf16 v[144:147], a[16:19], v[240:243], v[144:147]
    s_add_u32 s31, s31, 4224
    v_exp_f32 v122, v122
    v_mfma_f32_16x16x32_bf16 v[140:143], a[16:19], v[224:227], v[200:203]
    s_or_b32 s30, s30, 0x3000
    ds_read_b64_tr_b16 a[12:13], v2 offset:8480
    ds_read_b64_tr_b16 a[14:15], v2 offset:12704
    v_mfma_f32_16x16x32_bf16 v[140:143], a[20:23], v[228:231], v[140:143]
    s_cmp_eq_u32 s31, s92
    v_exp_f32 v123, v123
    v_mfma_f32_16x16x32_bf16 v[140:143], a[24:27], v[232:235], v[140:143]
    s_cselect_b32 s31, s93, s31
    ds_read_b64_tr_b16 a[8:9], v2 offset:32
    ds_read_b64_tr_b16 a[10:11], v2 offset:4256
    v_mfma_f32_16x16x32_bf16 v[140:143], a[28:31], v[236:239], v[140:143]
    v_exp_f32 v116, v116
    v_mfma_f32_16x16x32_bf16 v[136:139], a[28:31], v[220:223], v[196:199]
    v_exp_f32 v117, v117
    v_mfma_f32_16x16x32_bf16 v[136:139], a[24:27], v[216:219], v[136:139]
    v_exp_f32 v118, v118
    v_mfma_f32_16x16x32_bf16 v[136:139], a[20:23], v[212:215], v[136:139]
    v_exp_f32 v119, v119
    v_mfma_f32_16x16x32_bf16 v[136:139], a[16:19], v[208:211], v[136:139]
    v_exp_f32 v112, v112
    v_mfma_f32_16x16x32_bf16 a[68:71], a[64:67], v[148:151], a[68:71]
    s_mov_b32 m0, s31
    v_exp_f32 v113, v113
    v_mfma_f32_16x16x32_bf16 a[68:71], a[64:67], v[152:155], a[68:71]
    buffer_load_dwordx4 v0, s[20:23], s30 offen nt lds
    v_mfma_f32_16x16x32_bf16 a[72:75], a[64:67], v[156:159], a[72:75]
    s_add_u32 s30, s30, 1024
    v_exp_f32 v114, v114
    v_mfma_f32_16x16x32_bf16 a[72:75], a[64:67], v[160:163], a[72:75]
    s_add_u32 s31, s31, 4224
    v_exp_f32 v115, v115
    v_mfma_f32_16x16x32_bf16 a[76:79], a[64:67], v[164:167], a[76:79]
    s_or_b32 s30, s30, 0x3000
    v_exp_f32 v124, v124
    v_mfma_f32_16x16x32_bf16 a[76:79], a[64:67], v[168:171], a[76:79]
    s_waitcnt lgkmcnt(4)
    v_exp_f32 v125, v125
    v_mfma_f32_16x16x32_bf16 v[4:7], v[148:151], a[0:3], v[4:7]
    s_cmp_eq_u32 s31, s92
    ds_read_b64_tr_b16 a[16:17], v2 offset:256
    ds_read_b64_tr_b16 a[18:19], v2 offset:4480
    v_mfma_f32_16x16x32_bf16 v[4:7], v[152:155], a[4:7], v[4:7]
    s_cselect_b32 s31, s93, s31
    v_exp_f32 v126, v126
    v_mfma_f32_16x16x32_bf16 v[36:39], v[160:163], a[4:7], v[36:39]
    ds_read_b64_tr_b16 a[20:21], v2 offset:8704
    ds_read_b64_tr_b16 a[22:23], v2 offset:12928
    v_mfma_f32_16x16x32_bf16 v[36:39], v[156:159], a[0:3], v[36:39]
    v_exp_f32 v127, v127
    v_mfma_f32_16x16x32_bf16 v[68:71], v[164:167], a[0:3], v[68:71]
    ds_read_b64_tr_b16 a[28:29], v2 offset:8736
    ds_read_b64_tr_b16 a[30:31], v2 offset:12960
    v_mfma_f32_16x16x32_bf16 v[68:71], v[168:171], a[4:7], v[68:71]
    s_waitcnt lgkmcnt(6)
    v_exp_f32 v128, v128
    v_mfma_f32_16x16x32_bf16 v[72:75], v[168:171], a[12:15], v[72:75]
    s_mov_b32 m0, s31
    ds_read_b64_tr_b16 a[24:25], v2 offset:288
    ds_read_b64_tr_b16 a[26:27], v2 offset:4512
    v_mfma_f32_16x16x32_bf16 v[72:75], v[164:167], a[8:11], v[72:75]
    buffer_load_dwordx4 v0, s[20:23], s30 offen nt lds
    v_mfma_f32_16x16x32_bf16 v[40:43], v[156:159], a[8:11], v[40:43]
    s_add_u32 s30, s30, 1024
    v_exp_f32 v129, v129
    v_mfma_f32_16x16x32_bf16 v[40:43], v[160:163], a[12:15], v[40:43]
    s_add_u32 s31, s31, 4224
    v_exp_f32 v130, v130
    v_mfma_f32_16x16x32_bf16 v[8:11], v[152:155], a[12:15], v[8:11]
    s_or_b32 s30, s30, 0x3000
    v_exp_f32 v131, v131
    v_mfma_f32_16x16x32_bf16 v[8:11], v[148:151], a[8:11], v[8:11]
    s_waitcnt lgkmcnt(4)
    v_exp_f32 v132, v132
    v_mfma_f32_16x16x32_bf16 v[12:15], v[148:151], a[16:19], v[12:15]
    s_cmp_eq_u32 s31, s92
    ds_read_b64_tr_b16 a[0:1], v2 offset:512
    ds_read_b64_tr_b16 a[2:3], v2 offset:4736
    v_mfma_f32_16x16x32_bf16 v[12:15], v[152:155], a[20:23], v[12:15]
    s_cselect_b32 s31, s93, s31
    v_exp_f32 v133, v133
    v_mfma_f32_16x16x32_bf16 v[44:47], v[160:163], a[20:23], v[44:47]
    s_bitcmp1_b32 s94, 0
    ds_read_b64_tr_b16 a[4:5], v2 offset:8960
    ds_read_b64_tr_b16 a[6:7], v2 offset:13184
    v_mfma_f32_16x16x32_bf16 v[44:47], v[156:159], a[16:19], v[44:47]
    s_cselect_b64 s[68:69], s[46:47], s[30:31]
    v_exp_f32 v134, v134
    v_mfma_f32_16x16x32_bf16 v[76:79], v[164:167], a[16:19], v[76:79]
    s_cselect_b64 s[70:71], 0, s[44:45]
    ds_read_b64_tr_b16 a[12:13], v2 offset:8992
    ds_read_b64_tr_b16 a[14:15], v2 offset:13216
    v_mfma_f32_16x16x32_bf16 v[76:79], v[168:171], a[20:23], v[76:79]
    s_waitcnt lgkmcnt(6)
    v_exp_f32 v135, v135
    v_mfma_f32_16x16x32_bf16 v[80:83], v[168:171], a[28:31], v[80:83]
    s_mov_b32 m0, s69
    ds_read_b64_tr_b16 a[8:9], v2 offset:544
    ds_read_b64_tr_b16 a[10:11], v2 offset:4768
    v_mfma_f32_16x16x32_bf16 v[80:83], v[164:167], a[24:27], v[80:83]
    buffer_load_dwordx4 v0, s[20:23], s68 offen nt lds
    v_mfma_f32_16x16x32_bf16 v[48:51], v[156:159], a[24:27], v[48:51]
    s_add_u32 s30, s30, s70
    v_exp_f32 v144, v144
    v_mfma_f32_16x16x32_bf16 v[48:51], v[160:163], a[28:31], v[48:51]
    s_add_u32 s31, s31, s71
    v_exp_f32 v145, v145
    v_mfma_f32_16x16x32_bf16 v[16:19], v[152:155], a[28:31], v[16:19]
    s_or_b32 s30, s30, 0x3000
    v_exp_f32 v146, v146
    v_mfma_f32_16x16x32_bf16 v[16:19], v[148:151], a[24:27], v[16:19]
    s_waitcnt lgkmcnt(4)
    v_exp_f32 v147, v147
    v_mfma_f32_16x16x32_bf16 v[20:23], v[148:151], a[0:3], v[20:23]
    s_cmp_eq_u32 s31, s92
    ds_read_b64_tr_b16 a[16:17], v2 offset:768
    ds_read_b64_tr_b16 a[18:19], v2 offset:4992
    v_mfma_f32_16x16x32_bf16 v[20:23], v[152:155], a[4:7], v[20:23]
    s_cselect_b32 s31, s93, s31
    v_exp_f32 v140, v140
    v_mfma_f32_16x16x32_bf16 v[52:55], v[160:163], a[4:7], v[52:55]
    s_lshr_b32 s94, s94, 1
    ds_read_b64_tr_b16 a[20:21], v2 offset:9216
    ds_read_b64_tr_b16 a[22:23], v2 offset:13440
    v_mfma_f32_16x16x32_bf16 v[52:55], v[156:159], a[0:3], v[52:55]
    v_exp_f32 v141, v141
    v_mfma_f32_16x16x32_bf16 v[84:87], v[164:167], a[0:3], v[84:87]
    ds_read_b64_tr_b16 a[28:29], v2 offset:9248
    ds_read_b64_tr_b16 a[30:31], v2 offset:13472
    v_mfma_f32_16x16x32_bf16 v[84:87], v[168:171], a[4:7], v[84:87]
    s_waitcnt lgkmcnt(6)
    v_exp_f32 v142, v142
    v_mfma_f32_16x16x32_bf16 v[88:91], v[168:171], a[12:15], v[88:91]
    ds_read_b64_tr_b16 a[24:25], v2 offset:800
    ds_read_b64_tr_b16 a[26:27], v2 offset:5024
    v_mfma_f32_16x16x32_bf16 v[88:91], v[164:167], a[8:11], v[88:91]
    v_mfma_f32_16x16x32_bf16 v[56:59], v[156:159], a[8:11], v[56:59]
    s_lshr_b64 s[48:49], s[48:49], 2
    v_exp_f32 v143, v143
    v_mfma_f32_16x16x32_bf16 v[56:59], v[160:163], a[12:15], v[56:59]
    s_cbranch_scc1 L_gate2
L_back2:
    v_mfma_f32_16x16x32_bf16 v[24:27], v[152:155], a[12:15], v[24:27]
    s_waitcnt vmcnt(4) lgkmcnt(0)
    v_exp_f32 v136, v136
    v_mfma_f32_16x16x32_bf16 v[24:27], v[148:151], a[8:11], v[24:27]
    s_barrier
    v_mfma_f32_16x16x32_bf16 v[28:31], v[148:151], a[16:19], v[28:31]
    s_add_u32 m0, s28, 16896
    ds_read_b128 a[0:3], v1 offset:0
    v_cvt_pk_bf16_f32 v190, v120, v121
    v_mfma_f32_16x16x32_bf16 v[28:31], v[152:155], a[20:23], v[28:31]
    buffer_load_dwordx4 v0, s[16:19], s32 offen nt lds
    v_mfma_f32_16x16x32_bf16 v[60:63], v[160:163], a[20:23], v[60:63]
    ds_read_b128 a[4:7], v1 offset:256
    v_cvt_pk_bf16_f32 v191, v122, v123
    v_mfma_f32_16x16x32_bf16 v[60:63], v[156:159], a[16:19], v[60:63]
    v_exp_f32 v137, v137
    v_mfma_f32_16x16x32_bf16 v[92:95], v[164:167], a[16:19], v[92:95]
    ds_read_b128 a[8:11], v1 offset:512
    v_cvt_pk_bf16_f32 v182, v116, v117
    v_mfma_f32_16x16x32_bf16 v[92:95], v[168:171], a[20:23], v[92:95]
    v_exp_f32 v138, v138
    v_mfma_f32_16x16x32_bf16 v[96:99], v[168:171], a[28:31], v[96:99]
    ds_read_b128 a[12:15], v1 offset:768
    v_cvt_pk_bf16_f32 v183, v118, v119
    v_mfma_f32_16x16x32_bf16 v[96:99], v[164:167], a[24:27], v[96:99]
    v_exp_f32 v139, v139
    v_mfma_f32_16x16x32_bf16 v[64:67], v[156:159], a[24:27], v[64:67]
    v_cvt_pk_bf16_f32 v174, v112, v113
    v_cvt_pk_bf16_f32 v175, v114, v115
    v_mfma_f32_16x16x32_bf16 v[64:67], v[160:163], a[28:31], v[64:67]
    v_cvt_pk_bf16_f32 v176, v124, v125
    v_cvt_pk_bf16_f32 v177, v126, v127
    v_mfma_f32_16x16x32_bf16 v[32:35], v[152:155], a[28:31], v[32:35]
    v_cvt_pk_bf16_f32 v184, v128, v129
    v_cvt_pk_bf16_f32 v185, v130, v131
    v_mfma_f32_16x16x32_bf16 v[32:35], v[148:151], a[24:27], v[32:35]
    s_waitcnt lgkmcnt(2)
    v_cvt_pk_bf16_f32 v192, v132, v133
    v_cvt_pk_bf16_f32 v193, v134, v135
    v_mfma_f32_16x16x32_bf16 v[100:103], a[0:3], v[208:211], v[196:199]
    s_add_u32 m0, s28, 20096
    ds_read_b128 a[28:31], v1 offset:4992
    v_cvt_pk_bf16_f32 v194, v144, v145
    v_mfma_f32_16x16x32_bf16 v[100:103], a[4:7], v[212:215], v[100:103]
    s_waitcnt lgkmcnt(1)
    buffer_load_dwordx4 v0, s[16:19], s32 offen offset:1024 nt lds
    v_mfma_f32_16x16x32_bf16 v[100:103], a[8:11], v[216:219], v[100:103]
    ds_read_b128 a[24:27], v1 offset:4736
    v_cvt_pk_bf16_f32 v195, v146, v147
    v_mfma_f32_16x16x32_bf16 v[100:103], a[12:15], v[220:223], v[100:103]
    v_cvt_pk_bf16_f32 v186, v140, v141
    v_cvt_pk_bf16_f32 v187, v142, v143
    v_mfma_f32_16x16x32_bf16 v[104:107], a[12:15], v[236:239], v[200:203]
    ds_read_b128 a[20:23], v1 offset:4480
    v_cvt_pk_bf16_f32 v178, v136, v137
    v_mfma_f32_16x16x32_bf16 v[104:107], a[8:11], v[232:235], v[104:107]
    v_cvt_pk_bf16_f32 v179, v138, v139
    v_mfma_f32_16x16x32_bf16 v[104:107], a[4:7], v[228:231], v[104:107]
    ds_read_b128 a[16:19], v1 offset:4224
    v_mfma_f32_16x16x32_bf16 v[104:107], a[0:3], v[224:227], v[104:107]
    v_mfma_f32_16x16x32_bf16 v[108:111], a[0:3], v[240:243], v[204:207]
    v_mfma_f32_16x16x32_bf16 v[108:111], a[4:7], v[244:247], v[108:111]
    v_mfma_f32_16x16x32_bf16 v[108:111], a[8:11], v[248:251], v[108:111]
    v_mfma_f32_16x16x32_bf16 v[108:111], a[12:15], v[252:255], v[108:111]
    s_waitcnt lgkmcnt(2)
    v_exp_f32 v100, v100
    v_mfma_f32_16x16x32_bf16 v[120:123], a[28:31], v[252:255], v[204:207]
    s_add_u32 m0, s28, 23296
    ds_read_b128 a[0:3], v1 offset:8448
    v_mfma_f32_16x16x32_bf16 v[120:123], a[24:27], v[248:251], v[120:123]
    s_waitcnt lgkmcnt(1)
    buffer_load_dwordx4 v0, s[16:19], s32 offen offset:2048 nt lds
    v_mfma_f32_16x16x32_bf16 v[120:123], a[20:23], v[244:247], v[120:123]
    s_sub_u32 s99, 0, s99
    ds_read_b128 a[4:7], v1 offset:8704
    v_mfma_f32_16x16x32_bf16 v[120:123], a[16:19], v[240:243], v[120:123]
    v_exp_f32 v101, v101
    v_mfma_f32_16x16x32_bf16 v[116:119], a[16:19], v[224:227], v[200:203]
    ds_read_b128 a[8:11], v1 offset:8960
    v_cvt_pk_bf16_f32 v148, v100, v101
    v_mfma_f32_16x16x32_bf16 v[116:119], a[20:23], v[228:231], v[116:119]
    v_exp_f32 v102, v102
    v_mfma_f32_16x16x32_bf16 v[116:119], a[24:27], v[232:235], v[116:119]
    ds_read_b128 a[12:15], v1 offset:9216
    v_mfma_f32_16x16x32_bf16 v[116:119], a[28:31], v[236:239], v[116:119]
    v_exp_f32 v103, v103
    v_mfma_f32_16x16x32_bf16 v[112:115], a[28:31], v[220:223], v[196:199]
    v_exp_f32 v104, v104
    v_mfma_f32_16x16x32_bf16 v[112:115], a[24:27], v[216:219], v[112:115]
    v_exp_f32 v105, v105
    v_mfma_f32_16x16x32_bf16 v[112:115], a[20:23], v[212:215], v[112:115]
    v_exp_f32 v106, v106
    v_mfma_f32_16x16x32_bf16 v[112:115], a[16:19], v[208:211], v[112:115]
    s_waitcnt lgkmcnt(2)
    v_exp_f32 v107, v107
    v_mfma_f32_16x16x32_bf16 v[124:127], a[0:3], v[208:211], v[196:199]
    s_add_u32 m0, s28, 26496
    ds_read_b128 a[28:31], v1 offset:13440
    v_cvt_pk_bf16_f32 v149, v102, v103
    v_mfma_f32_16x16x32_bf16 v[124:127], a[4:7], v[212:215], v[124:127]
    s_waitcnt lgkmcnt(1)
    buffer_load_dwordx4 v0, s[16:19], s32 offen offset:3072 nt lds
    v_mfma_f32_16x16x32_bf16 v[124:127], a[8:11], v[216:219], v[124:127]
    s_add_u32 s32, s32, 16384
    ds_read_b128 a[24:27], v1 offset:13184
    v_cvt_pk_bf16_f32 v156, v104, v105
    v_mfma_f32_16x16x32_bf16 v[124:127], a[12:15], v[220:223], v[124:127]
    v_exp_f32 v108, v108
    v_mfma_f32_16x16x32_bf16 v[128:131], a[12:15], v[236:239], v[200:203]
    ds_read_b128 a[20:23], v1 offset:12928
    v_cvt_pk_bf16_f32 v157, v106, v107
    v_mfma_f32_16x16x32_bf16 v[128:131], a[8:11], v[232:235], v[128:131]
    v_exp_f32 v109, v109
    v_mfma_f32_16x16x32_bf16 v[128:131], a[4:7], v[228:231], v[128:131]
    ds_read_b128 a[16:19], v1 offset:12672
    v_cvt_pk_bf16_f32 v164, v108, v109
    v_mfma_f32_16x16x32_bf16 v[128:131], a[0:3], v[224:227], v[128:131]
    v_exp_f32 v110, v110
    v_mfma_f32_16x16x32_bf16 v[132:135], a[0:3], v[240:243], v[204:207]
    v_exp_f32 v111, v111
    v_mfma_f32_16x16x32_bf16 v[132:135], a[4:7], v[244:247], v[132:135]
    s_lshr_b64 s[48:49], s[48:49], 2
    v_exp_f32 v120, v120
    v_mfma_f32_16x16x32_bf16 v[132:135], a[8:11], v[248:251], v[132:135]
    s_cbranch_scc1 L_gate3
L_back3:
    v_cvt_pk_bf16_f32 v165, v110, v111
    v_mfma_f32_16x16x32_bf16 v[132:135], a[12:15], v[252:255], v[132:135]
    s_waitcnt vmcnt(4) lgkmcnt(2)
    v_exp_f32 v121, v121
    v_mfma_f32_16x16x32_bf16 v[144:147], a[28:31], v[252:255], v[204:207]
    s_mov_b32 m0, s31
    ds_read_b64_tr_b16 a[0:1], v2 offset:16896
    ds_read_b64_tr_b16 a[2:3], v2 offset:21120
    v_mfma_f32_16x16x32_bf16 v[144:147], a[24:27], v[248:251], v[144:147]
    s_waitcnt lgkmcnt(2)
    buffer_load_dwordx4 v0, s[20:23], s30 offen nt lds
    v_mfma_f32_16x16x32_bf16 v[144:147], a[20:23], v[244:247], v[144:147]
    s_add_u32 s30, s30, 1024
    ds_read_b64_tr_b16 a[4:5], v2 offset:25344
    ds_read_b64_tr_b16 a[6:7], v2 offset:29568
    v_mfma_f32_16x16x32_bf16 v[144:147], a[16:19], v[240:243], v[144:147]
    s_add_u32 s31, s31, 4224
    v_exp_f32 v122, v122
    v_mfma_f32_16x16x32_bf16 v[140:143], a[16:19], v[224:227], v[200:203]
    s_or_b32 s30, s30, 0x3000
    ds_read_b64_tr_b16 a[12:13], v2 offset:25376
    ds_read_b64_tr_b16 a[14:15], v2 offset:29600
    v_mfma_f32_16x16x32_bf16 v[140:143], a[20:23], v[228:231], v[140:143]
    s_cmp_eq_u32 s31, s92
    v_exp_f32 v123, v123
    v_mfma_f32_16x16x32_bf16 v[140:143], a[24:27], v[232:235], v[140:143]
    s_cselect_b32 s31, s93, s31
    ds_read_b64_tr_b16 a[8:9], v2 offset:16928
    ds_read_b64_tr_b16 a[10:11], v2 offset:21152
    v_mfma_f32_16x16x32_bf16 v[140:143], a[28:31], v[236:239], v[140:143]
    v_exp_f32 v116, v116
    v_mfma_f32_16x16x32_bf16 v[136:139], a[28:31], v[220:223], v[196:199]
    v_exp_f32 v117, v117
    v_mfma_f32_16x16x32_bf16 v[136:139], a[24:27], v[216:219], v[136:139]
    v_exp_f32 v118, v118
    v_mfma_f32_16x16x32_bf16 v[136:139], a[20:23], v[212:215], v[136:139]
    v_exp_f32 v119, v119
    v_mfma_f32_16x16x32_bf16 v[136:139], a[16:19], v[208:211], v[136:139]
    v_exp_f32 v112, v112
    v_mfma_f32_16x16x32_bf16 a[68:71], a[64:67], v[172:175], a[68:71]
    s_mov_b32 m0, s31
    v_exp_f32 v113, v113
    v_mfma_f32_16x16x32_bf16 a[68:71], a[64:67], v[176:179], a[68:71]
    buffer_load_dwordx4 v0, s[20:23], s30 offen nt lds
    v_mfma_f32_16x16x32_bf16 a[72:75], a[64:67], v[180:183], a[72:75]
    s_add_u32 s30, s30, 1024
    v_exp_f32 v114, v114
    v_mfma_f32_16x16x32_bf16 a[72:75], a[64:67], v[184:187], a[72:75]
    s_add_u32 s31, s31, 4224
    v_exp_f32 v115, v115
    v_mfma_f32_16x16x32_bf16 a[76:79], a[64:67], v[188:191], a[76:79]
    s_or_b32 s30, s30, 0x3000
    v_exp_f32 v124, v124
    v_mfma_f32_16x16x32_bf16 a[76:79], a[64:67], v[192:195], a[76:79]
    s_waitcnt lgkmcnt(4)
    v_exp_f32 v125, v125
    v_mfma_f32_16x16x32_bf16 v[4:7], v[172:175], a[0:3], v[4:7]
    s_cmp_eq_u32 s31, s92
    ds_read_b64_tr_b16 a[16:17], v2 offset:17152
    ds_read_b64_tr_b16 a[18:19], v2 offset:21376
    v_mfma_f32_16x16x32_bf16 v[4:7], v[176:179], a[4:7], v[4:7]
    s_cselect_b32 s31, s93, s31
    v_exp_f32 v126, v126
    v_mfma_f32_16x16x32_bf16 v[36:39], v[184:187], a[4:7], v[36:39]
    ds_read_b64_tr_b16 a[20:21], v2 offset:25600
    ds_read_b64_tr_b16 a[22:23], v2 offset:29824
    v_mfma_f32_16x16x32_bf16 v[36:39], v[180:183], a[0:3], v[36:39]
    v_exp_f32 v127, v127
    v_mfma_f32_16x16x32_bf16 v[68:71], v[188:191], a[0:3], v[68:71]
    ds_read_b64_tr_b16 a[28:29], v2 offset:25632
    ds_read_b64_tr_b16 a[30:31], v2 offset:29856
    v_mfma_f32_16x16x32_bf16 v[68:71], v[192:195], a[4:7], v[68:71]
    s_waitcnt lgkmcnt(6)
    v_exp_f32 v128, v128
    v_mfma_f32_16x16x32_bf16 v[72:75], v[192:195], a[12:15], v[72:75]
    s_mov_b32 m0, s31
    ds_read_b64_tr_b16 a[24:25], v2 offset:17184
    ds_read_b64_tr_b16 a[26:27], v2 offset:21408
    v_mfma_f32_16x16x32_bf16 v[72:75], v[188:191], a[8:11], v[72:75]
    buffer_load_dwordx4 v0, s[20:23], s30 offen nt lds
    v_mfma_f32_16x16x32_bf16 v[40:43], v[180:183], a[8:11], v[40:43]
    s_add_u32 s30, s30, 1024
    v_exp_f32 v129, v129
    v_mfma_f32_16x16x32_bf16 v[40:43], v[184:187], a[12:15], v[40:43]
    s_add_u32 s31, s31, 4224
    v_exp_f32 v130, v130
    v_mfma_f32_16x16x32_bf16 v[8:11], v[176:179], a[12:15], v[8:11]
    s_or_b32 s30, s30, 0x3000
    v_exp_f32 v131, v131
    v_mfma_f32_16x16x32_bf16 v[8:11], v[172:175], a[8:11], v[8:11]
    s_waitcnt lgkmcnt(4)
    v_exp_f32 v132, v132
    v_mfma_f32_16x16x32_bf16 v[12:15], v[172:175], a[16:19], v[12:15]
    s_cmp_eq_u32 s31, s92
    ds_read_b64_tr_b16 a[0:1], v2 offset:17408
    ds_read_b64_tr_b16 a[2:3], v2 offset:21632
    v_mfma_f32_16x16x32_bf16 v[12:15], v[176:179], a[20:23], v[12:15]
    s_cselect_b32 s31, s93, s31
    v_exp_f32 v133, v133
    v_mfma_f32_16x16x32_bf16 v[44:47], v[184:187], a[20:23], v[44:47]
    s_bitcmp1_b32 s94, 0
    ds_read_b64_tr_b16 a[4:5], v2 offset:25856
    ds_read_b64_tr_b16 a[6:7], v2 offset:30080
    v_mfma_f32_16x16x32_bf16 v[44:47], v[180:183], a[16:19], v[44:47]
    s_cselect_b64 s[68:69], s[46:47], s[30:31]
    v_exp_f32 v134, v134
    v_mfma_f32_16x16x32_bf16 v[76:79], v[188:191], a[16:19], v[76:79]
    s_cselect_b64 s[70:71], 0, s[44:45]
    ds_read_b64_tr_b16 a[12:13], v2 offset:25888
    ds_read_b64_tr_b16 a[14:15], v2 offset:30112
    v_mfma_f32_16x16x32_bf16 v[76:79], v[192:195], a[20:23], v[76:79]
    s_waitcnt lgkmcnt(6)
    v_exp_f32 v135, v135
    v_mfma_f32_16x16x32_bf16 v[80:83], v[192:195], a[28:31], v[80:83]
    s_mov_b32 m0, s69
    ds_read_b64_tr_b16 a[8:9], v2 offset:17440
    ds_read_b64_tr_b16 a[10:11], v2 offset:21664
    v_mfma_f32_16x16x32_bf16 v[80:83], v[188:191], a[24:27], v[80:83]
    buffer_load_dwordx4 v0, s[20:23], s68 offen nt lds
    v_mfma_f32_16x16x32_bf16 v[48:51], v[180:183], a[24:27], v[48:51]
    s_add_u32 s30, s30, s70
    v_exp_f32 v144, v144
    v_mfma_f32_16x16x32_bf16 v[48:51], v[184:187], a[28:31], v[48:51]
    s_add_u32 s31, s31, s71
    v_exp_f32 v145, v145
    v_mfma_f32_16x16x32_bf16 v[16:19], v[176:179], a[28:31], v[16:19]
    s_or_b32 s30, s30, 0x3000
    v_exp_f32 v146, v146
    v_mfma_f32_16x16x32_bf16 v[16:19], v[172:175], a[24:27], v[16:19]
    s_waitcnt lgkmcnt(4)
    v_exp_f32 v147, v147
    v_mfma_f32_16x16x32_bf16 v[20:23], v[172:175], a[0:3], v[20:23]
    s_cmp_eq_u32 s31, s92
    ds_read_b64_tr_b16 a[16:17], v2 offset:17664
    ds_read_b64_tr_b16 a[18:19], v2 offset:21888
    v_mfma_f32_16x16x32_bf16 v[20:23], v[176:179], a[4:7], v[20:23]
    s_cselect_b32 s31, s93, s31
    v_exp_f32 v140, v140
    v_mfma_f32_16x16x32_bf16 v[52:55], v[184:187], a[4:7], v[52:55]
    s_lshr_b32 s94, s94, 1
    ds_read_b64_tr_b16 a[20:21], v2 offset:26112
    ds_read_b64_tr_b16 a[22:23], v2 offset:30336
    v_mfma_f32_16x16x32_bf16 v[52:55], v[180:183], a[0:3], v[52:55]
    v_exp_f32 v141, v141
    v_mfma_f32_16x16x32_bf16 v[84:87], v[188:191], a[0:3], v[84:87]
    ds_read_b64_tr_b16 a[28:29], v2 offset:26144
    ds_read_b64_tr_b16 a[30:31], v2 offset:30368
    v_mfma_f32_16x16x32_bf16 v[84:87], v[192:195], a[4:7], v[84:87]
    s_waitcnt lgkmcnt(6)
    v_exp_f32 v142, v142
    v_mfma_f32_16x16x32_bf16 v[88:91], v[192:195], a[12:15], v[88:91]
    s_cmp_lt_u32 s32, 262144
    ds_read_b64_tr_b16 a[24:25], v2 offset:17696
    ds_read_b64_tr_b16 a[26:27], v2 offset:21920
    v_mfma_f32_16x16x32_bf16 v[88:91], v[188:191], a[8:11], v[88:91]
    s_cbranch_scc1 L_loop
L_last:
    v_mfma_f32_16x16x32_bf16 v[56:59], v[180:183], a[8:11], v[56:59]
    v_exp_f32 v143, v143
    v_mfma_f32_16x16x32_bf16 v[56:59], v[184:187], a[12:15], v[56:59]
    v_add_u32 v2, s99, v2
    v_mfma_f32_16x16x32_bf16 v[24:27], v[176:179], a[12:15], v[24:27]
    s_waitcnt vmcnt(4) lgkmcnt(0)
    v_exp_f32 v136, v136
    v_mfma_f32_16x16x32_bf16 v[24:27], v[172:175], a[8:11], v[24:27]
    s_barrier
    v_mfma_f32_16x16x32_bf16 v[28:31], v[172:175], a[16:19], v[28:31]
    ds_read_b128 a[0:3], v1 offset:16896
    v_cvt_pk_bf16_f32 v166, v120, v121
    v_mfma_f32_16x16x32_bf16 v[28:31], v[176:179], a[20:23], v[28:31]
    v_mfma_f32_16x16x32_bf16 v[60:63], v[184:187], a[20:23], v[60:63]
    ds_read_b128 a[4:7], v1 offset:17152
    v_cvt_pk_bf16_f32 v167, v122, v123
    v_mfma_f32_16x16x32_bf16 v[60:63], v[180:183], a[16:19], v[60:63]
    v_exp_f32 v137, v137
    v_mfma_f32_16x16x32_bf16 v[92:95], v[188:191], a[16:19], v[92:95]
    ds_read_b128 a[8:11], v1 offset:17408
    v_cvt_pk_bf16_f32 v158, v116, v117
    v_mfma_f32_16x16x32_bf16 v[92:95], v[192:195], a[20:23], v[92:95]
    v_exp_f32 v138, v138
    v_mfma_f32_16x16x32_bf16 v[96:99], v[192:195], a[28:31], v[96:99]
    ds_read_b128 a[12:15], v1 offset:17664
    v_cvt_pk_bf16_f32 v159, v118, v119
    v_mfma_f32_16x16x32_bf16 v[96:99], v[188:191], a[24:27], v[96:99]
    v_exp_f32 v139, v139
    v_mfma_f32_16x16x32_bf16 v[64:67], v[180:183], a[24:27], v[64:67]
    v_cvt_pk_bf16_f32 v150, v112, v113
    v_cvt_pk_bf16_f32 v151, v114, v115
    v_mfma_f32_16x16x32_bf16 v[64:67], v[184:187], a[28:31], v[64:67]
    v_cvt_pk_bf16_f32 v152, v124, v125
    v_cvt_pk_bf16_f32 v153, v126, v127
    v_mfma_f32_16x16x32_bf16 v[32:35], v[176:179], a[28:31], v[32:35]
    v_cvt_pk_bf16_f32 v160, v128, v129
    v_cvt_pk_bf16_f32 v161, v130, v131
    v_mfma_f32_16x16x32_bf16 v[32:35], v[172:175], a[24:27], v[32:35]
    s_waitcnt lgkmcnt(2)
    v_cvt_pk_bf16_f32 v168, v132, v133
    v_cvt_pk_bf16_f32 v169, v134, v135
    v_mfma_f32_16x16x32_bf16 v[100:103], a[0:3], v[208:211], v[196:199]
    ds_read_b128 a[28:31], v1 offset:21888
    v_cvt_pk_bf16_f32 v170, v144, v145
    v_mfma_f32_16x16x32_bf16 v[100:103], a[4:7], v[212:215], v[100:103]
    s_waitcnt lgkmcnt(1)
    v_mfma_f32_16x16x32_bf16 v[100:103], a[8:11], v[216:219], v[100:103]
    ds_read_b128 a[24:27], v1 offset:21632
    v_cvt_pk_bf16_f32 v171, v146, v147
    v_mfma_f32_16x16x32_bf16 v[100:103], a[12:15], v[220:223], v[100:103]
    v_cvt_pk_bf16_f32 v162, v140, v141
    v_cvt_pk_bf16_f32 v163, v142, v143
    v_mfma_f32_16x16x32_bf16 v[104:107], a[12:15], v[236:239], v[200:203]
    ds_read_b128 a[20:23], v1 offset:21376
    v_cvt_pk_bf16_f32 v154, v136, v137
    v_mfma_f32_16x16x32_bf16 v[104:107], a[8:11], v[232:235], v[104:107]
    v_cvt_pk_bf16_f32 v155, v138, v139
    v_mfma_f32_16x16x32_bf16 v[104:107], a[4:7], v[228:231], v[104:107]
    ds_read_b128 a[16:19], v1 offset:21120
    v_mfma_f32_16x16x32_bf16 v[104:107], a[0:3], v[224:227], v[104:107]
    v_mfma_f32_16x16x32_bf16 v[108:111], a[0:3], v[240:243], v[204:207]
    v_mfma_f32_16x16x32_bf16 v[108:111], a[4:7], v[244:247], v[108:111]
    v_mfma_f32_16x16x32_bf16 v[108:111], a[8:11], v[248:251], v[108:111]
    v_mfma_f32_16x16x32_bf16 v[108:111], a[12:15], v[252:255], v[108:111]
    s_waitcnt lgkmcnt(2)
    v_exp_f32 v100, v100
    v_mfma_f32_16x16x32_bf16 v[120:123], a[28:31], v[252:255], v[204:207]
    ds_read_b128 a[0:3], v1 offset:25344
    v_mfma_f32_16x16x32_bf16 v[120:123], a[24:27], v[248:251], v[120:123]
    s_waitcnt lgkmcnt(1)
    v_mfma_f32_16x16x32_bf16 v[120:123], a[20:23], v[244:247], v[120:123]
    ds_read_b128 a[4:7], v1 offset:25600
    v_mfma_f32_16x16x32_bf16 v[120:123], a[16:19], v[240:243], v[120:123]
    v_exp_f32 v101, v101
    v_mfma_f32_16x16x32_bf16 v[116:119], a[16:19], v[224:227], v[200:203]
    ds_read_b128 a[8:11], v1 offset:25856
    v_cvt_pk_bf16_f32 v172, v100, v101
    v_mfma_f32_16x16x32_bf16 v[116:119], a[20:23], v[228:231], v[116:119]
    v_exp_f32 v102, v102
    v_mfma_f32_16x16x32_bf16 v[116:119], a[24:27], v[232:235], v[116:119]
    ds_read_b128 a[12:15], v1 offset:26112
    v_mfma_f32_16x16x32_bf16 v[116:119], a[28:31], v[236:239], v[116:119]
    v_exp_f32 v103, v103
    v_mfma_f32_16x16x32_bf16 v[112:115], a[28:31], v[220:223], v[196:199]
    v_exp_f32 v104, v104
    v_mfma_f32_16x16x32_bf16 v[112:115], a[24:27], v[216:219], v[112:115]
    v_exp_f32 v105, v105
    v_mfma_f32_16x16x32_bf16 v[112:115], a[20:23], v[212:215], v[112:115]
    v_exp_f32 v106, v106
    v_mfma_f32_16x16x32_bf16 v[112:115], a[16:19], v[208:211], v[112:115]
    s_waitcnt lgkmcnt(2)
    v_exp_f32 v107, v107
    v_mfma_f32_16x16x32_bf16 v[124:127], a[0:3], v[208:211], v[196:199]
    ds_read_b128 a[28:31], v1 offset:30336
    v_cvt_pk_bf16_f32 v173, v102, v103
    v_mfma_f32_16x16x32_bf16 v[124:127], a[4:7], v[212:215], v[124:127]
    s_waitcnt lgkmcnt(1)
    v_mfma_f32_16x16x32_bf16 v[124:127], a[8:11], v[216:219], v[124:127]
    ds_read_b128 a[24:27], v1 offset:30080
    v_cvt_pk_bf16_f32 v180, v104, v105
    v_mfma_f32_16x16x32_bf16 v[124:127], a[12:15], v[220:223], v[124:127]
    v_exp_f32 v108, v108
    v_mfma_f32_16x16x32_bf16 v[128:131], a[12:15], v[236:239], v[200:203]
    ds_read_b128 a[20:23], v1 offset:29824
    v_cvt_pk_bf16_f32 v181, v106, v107
    v_mfma_f32_16x16x32_bf16 v[128:131], a[8:11], v[232:235], v[128:131]
    v_exp_f32 v109, v109
    v_mfma_f32_16x16x32_bf16 v[128:131], a[4:7], v[228:231], v[128:131]
    ds_read_b128 a[16:19], v1 offset:29568
    v_cvt_pk_bf16_f32 v188, v108, v109
    v_mfma_f32_16x16x32_bf16 v[128:131], a[0:3], v[224:227], v[128:131]
    v_exp_f32 v110, v110
    v_mfma_f32_16x16x32_bf16 v[132:135], a[0:3], v[240:243], v[204:207]
    v_exp_f32 v111, v111
    v_mfma_f32_16x16x32_bf16 v[132:135], a[4:7], v[244:247], v[132:135]
    v_exp_f32 v120, v120
    v_mfma_f32_16x16x32_bf16 v[132:135], a[8:11], v[248:251], v[132:135]
    v_cvt_pk_bf16_f32 v189, v110, v111
    v_mfma_f32_16x16x32_bf16 v[132:135], a[12:15], v[252:255], v[132:135]
    s_waitcnt lgkmcnt(2)
    v_exp_f32 v121, v121
    v_mfma_f32_16x16x32_bf16 v[144:147], a[28:31], v[252:255], v[204:207]
    ds_read_b64_tr_b16 a[0:1], v2 offset:0
    ds_read_b64_tr_b16 a[2:3], v2 offset:4224
    v_mfma_f32_16x16x32_bf16 v[144:147], a[24:27], v[248:251], v[144:147]
    s_waitcnt lgkmcnt(2)
    v_cvt_pk_bf16_f32 v190, v120, v121
    v_mfma_f32_16x16x32_bf16 v[144:147], a[20:23], v[244:247], v[144:147]
    ds_read_b64_tr_b16 a[4:5], v2 offset:8448
    ds_read_b64_tr_b16 a[6:7], v2 offset:12672
    v_mfma_f32_16x16x32_bf16 v[144:147], a[16:19], v[240:243], v[144:147]
    v_exp_f32 v122, v122
    v_mfma_f32_16x16x32_bf16 v[140:143], a[16:19], v[224:227], v[200:203]
    ds_read_b64_tr_b16 a[12:13], v2 offset:8480
    ds_read_b64_tr_b16 a[14:15], v2 offset:12704
    v_mfma_f32_16x16x32_bf16 v[140:143], a[20:23], v[228:231], v[140:143]
    v_exp_f32 v123, v123
    v_mfma_f32_16x16x32_bf16 v[140:143], a[24:27], v[232:235], v[140:143]
    ds_read_b64_tr_b16 a[8:9], v2 offset:32
    ds_read_b64_tr_b16 a[10:11], v2 offset:4256
    v_mfma_f32_16x16x32_bf16 v[140:143], a[28:31], v[236:239], v[140:143]
    v_exp_f32 v116, v116
    v_mfma_f32_16x16x32_bf16 v[136:139], a[28:31], v[220:223], v[196:199]
    v_exp_f32 v117, v117
    v_mfma_f32_16x16x32_bf16 v[136:139], a[24:27], v[216:219], v[136:139]
    v_exp_f32 v118, v118
    v_mfma_f32_16x16x32_bf16 v[136:139], a[20:23], v[212:215], v[136:139]
    v_exp_f32 v119, v119
    v_mfma_f32_16x16x32_bf16 v[136:139], a[16:19], v[208:211], v[136:139]
    v_exp_f32 v112, v112
    v_mfma_f32_16x16x32_bf16 a[68:71], a[64:67], v[148:151], a[68:71]
    v_exp_f32 v113, v113
    v_mfma_f32_16x16x32_bf16 a[68:71], a[64:67], v[152:155], a[68:71]
    v_cvt_pk_bf16_f32 v191, v122, v123
    v_cvt_pk_bf16_f32 v182, v116, v117
    v_mfma_f32_16x16x32_bf16 a[72:75], a[64:67], v[156:159], a[72:75]
    v_exp_f32 v114, v114
    v_mfma_f32_16x16x32_bf16 a[72:75], a[64:67], v[160:163], a[72:75]
    v_exp_f32 v115, v115
    v_mfma_f32_16x16x32_bf16 a[76:79], a[64:67], v[164:167], a[76:79]
    v_exp_f32 v124, v124
    v_mfma_f32_16x16x32_bf16 a[76:79], a[64:67], v[168:171], a[76:79]
    s_waitcnt lgkmcnt(4)
    v_exp_f32 v125, v125
    v_mfma_f32_16x16x32_bf16 v[4:7], v[148:151], a[0:3], v[4:7]
    ds_read_b64_tr_b16 a[16:17], v2 offset:256
    ds_read_b64_tr_b16 a[18:19], v2 offset:4480
    v_mfma_f32_16x16x32_bf16 v[4:7], v[152:155], a[4:7], v[4:7]
    v_exp_f32 v126, v126
    v_mfma_f32_16x16x32_bf16 v[36:39], v[160:163], a[4:7], v[36:39]
    ds_read_b64_tr_b16 a[20:21], v2 offset:8704
    ds_read_b64_tr_b16 a[22:23], v2 offset:12928
    v_mfma_f32_16x16x32_bf16 v[36:39], v[156:159], a[0:3], v[36:39]
    v_exp_f32 v127, v127
    v_mfma_f32_16x16x32_bf16 v[68:71], v[164:167], a[0:3], v[68:71]
    ds_read_b64_tr_b16 a[28:29], v2 offset:8736
    ds_read_b64_tr_b16 a[30:31], v2 offset:12960
    v_mfma_f32_16x16x32_bf16 v[68:71], v[168:171], a[4:7], v[68:71]
    s_waitcnt lgkmcnt(6)
    v_exp_f32 v128, v128
    v_mfma_f32_16x16x32_bf16 v[72:75], v[168:171], a[12:15], v[72:75]
    ds_read_b64_tr_b16 a[24:25], v2 offset:288
    ds_read_b64_tr_b16 a[26:27], v2 offset:4512
    v_mfma_f32_16x16x32_bf16 v[72:75], v[164:167], a[8:11], v[72:75]
    v_cvt_pk_bf16_f32 v183, v118, v119
    v_cvt_pk_bf16_f32 v174, v112, v113
    v_mfma_f32_16x16x32_bf16 v[40:43], v[156:159], a[8:11], v[40:43]
    v_exp_f32 v129, v129
    v_mfma_f32_16x16x32_bf16 v[40:43], v[160:163], a[12:15], v[40:43]
    v_exp_f32 v130, v130
    v_mfma_f32_16x16x32_bf16 v[8:11], v[152:155], a[12:15], v[8:11]
    v_exp_f32 v131, v131
    v_mfma_f32_16x16x32_bf16 v[8:11], v[148:151], a[8:11], v[8:11]
    s_waitcnt lgkmcnt(4)
    v_exp_f32 v132, v132
    v_mfma_f32_16x16x32_bf16 v[12:15], v[148:151], a[16:19], v[12:15]
    ds_read_b64_tr_b16 a[0:1], v2 offset:512
    ds_read_b64_tr_b16 a[2:3], v2 offset:4736
    v_mfma_f32_16x16x32_bf16 v[12:15], v[152:155], a[20:23], v[12:15]
    v_exp_f32 v133, v133
    v_mfma_f32_16x16x32_bf16 v[44:47], v[160:163], a[20:23], v[44:47]
    ds_read_b64_tr_b16 a[4:5], v2 offset:8960
    ds_read_b64_tr_b16 a[6:7], v2 offset:13184
    v_mfma_f32_16x16x32_bf16 v[44:47], v[156:159], a[16:19], v[44:47]
    v_exp_f32 v134, v134
    v_mfma_f32_16x16x32_bf16 v[76:79], v[164:167], a[16:19], v[76:79]
    ds_read_b64_tr_b16 a[12:13], v2 offset:8992
    ds_read_b64_tr_b16 a[14:15], v2 offset:13216
    v_mfma_f32_16x16x32_bf16 v[76:79], v[168:171], a[20:23], v[76:79]
    s_waitcnt lgkmcnt(6)
    v_exp_f32 v135, v135
    v_mfma_f32_16x16x32_bf16 v[80:83], v[168:171], a[28:31], v[80:83]
    ds_read_b64_tr_b16 a[8:9], v2 offset:544
    ds_read_b64_tr_b16 a[10:11], v2 offset:4768
    v_mfma_f32_16x16x32_bf16 v[80:83], v[164:167], a[24:27], v[80:83]
    v_cvt_pk_bf16_f32 v175, v114, v115
    v_cvt_pk_bf16_f32 v176, v124, v125
    v_mfma_f32_16x16x32_bf16 v[48:51], v[156:159], a[24:27], v[48:51]
    v_exp_f32 v144, v144
    v_mfma_f32_16x16x32_bf16 v[48:51], v[160:163], a[28:31], v[48:51]
    v_exp_f32 v145, v145
    v_mfma_f32_16x16x32_bf16 v[16:19], v[152:155], a[28:31], v[16:19]
    v_exp_f32 v146, v146
    v_mfma_f32_16x16x32_bf16 v[16:19], v[148:151], a[24:27], v[16:19]
    s_waitcnt lgkmcnt(4)
    v_exp_f32 v147, v147
    v_mfma_f32_16x16x32_bf16 v[20:23], v[148:151], a[0:3], v[20:23]
    ds_read_b64_tr_b16 a[16:17], v2 offset:768
    ds_read_b64_tr_b16 a[18:19], v2 offset:4992
    v_mfma_f32_16x16x32_bf16 v[20:23], v[152:155], a[4:7], v[20:23]
    v_exp_f32 v140, v140
    v_mfma_f32_16x16x32_bf16 v[52:55], v[160:163], a[4:7], v[52:55]
    ds_read_b64_tr_b16 a[20:21], v2 offset:9216
    ds_read_b64_tr_b16 a[22:23], v2 offset:13440
    v_mfma_f32_16x16x32_bf16 v[52:55], v[156:159], a[0:3], v[52:55]
    v_exp_f32 v141, v141
    v_mfma_f32_16x16x32_bf16 v[84:87], v[164:167], a[0:3], v[84:87]
    ds_read_b64_tr_b16 a[28:29], v2 offset:9248
    ds_read_b64_tr_b16 a[30:31], v2 offset:13472
    v_mfma_f32_16x16x32_bf16 v[84:87], v[168:171], a[4:7], v[84:87]
    s_waitcnt lgkmcnt(6)
    v_exp_f32 v142, v142
    v_mfma_f32_16x16x32_bf16 v[88:91], v[168:171], a[12:15], v[88:91]
    ds_read_b64_tr_b16 a[24:25], v2 offset:800
    ds_read_b64_tr_b16 a[26:27], v2 offset:5024
    v_mfma_f32_16x16x32_bf16 v[88:91], v[164:167], a[8:11], v[88:91]
    v_cvt_pk_bf16_f32 v177, v126, v127
    v_cvt_pk_bf16_f32 v184, v128, v129
    v_mfma_f32_16x16x32_bf16 v[56:59], v[156:159], a[8:11], v[56:59]
    v_exp_f32 v143, v143
    v_mfma_f32_16x16x32_bf16 v[56:59], v[160:163], a[12:15], v[56:59]
    v_cvt_pk_bf16_f32 v185, v130, v131
    v_cvt_pk_bf16_f32 v192, v132, v133
    v_mfma_f32_16x16x32_bf16 v[24:27], v[152:155], a[12:15], v[24:27]
    v_exp_f32 v136, v136
    v_mfma_f32_16x16x32_bf16 v[24:27], v[148:151], a[8:11], v[24:27]
    v_cvt_pk_bf16_f32 v193, v134, v135
    v_cvt_pk_bf16_f32 v194, v144, v145
L_tail:
    s_waitcnt lgkmcnt(4)
    v_mfma_f32_16x16x32_bf16 v[28:31], v[148:151], a[16:19], v[28:31]
    s_mul_i32 s37, s3, 12288
    v_exp_f32 v137, v137
    v_mfma_f32_16x16x32_bf16 v[28:31], v[152:155], a[20:23], v[28:31]
    s_add_u32 s38, s37, 4096
    v_exp_f32 v138, v138
    v_mfma_f32_16x16x32_bf16 v[60:63], v[160:163], a[20:23], v[60:63]
    s_add_u32 s39, s37, 8192
    v_exp_f32 v139, v139
    v_mfma_f32_16x16x32_bf16 v[60:63], v[156:159], a[16:19], v[60:63]
    v_cvt_pk_bf16_f32 v195, v146, v147
    v_cvt_pk_bf16_f32 v186, v140, v141
    v_mfma_f32_16x16x32_bf16 v[92:95], v[164:167], a[16:19], v[92:95]
    v_cvt_pk_bf16_f32 v187, v142, v143
    v_cvt_pk_bf16_f32 v178, v136, v137
    v_mfma_f32_16x16x32_bf16 v[92:95], v[168:171], a[20:23], v[92:95]
    s_waitcnt lgkmcnt(0)
    v_cvt_pk_bf16_f32 v179, v138, v139
    v_accvgpr_read_b32 v197, a80
    v_mfma_f32_16x16x32_bf16 v[96:99], v[168:171], a[28:31], v[96:99]
    v_accvgpr_read_b32 v198, a81
    v_accvgpr_read_b32 v199, a82
    v_mfma_f32_16x16x32_bf16 v[96:99], v[164:167], a[24:27], v[96:99]
    v_accvgpr_read_b32 v200, a83
    v_accvgpr_read_b32 v201, a84
    s_waitcnt vmcnt(0)
    s_barrier
    v_mfma_f32_16x16x32_bf16 v[64:67], v[156:159], a[24:27], v[64:67]
    ds_read_b64_tr_b16 a[88:89], v2 offset:16896
    ds_read_b64_tr_b16 a[90:91], v2 offset:21120
    v_mfma_f32_16x16x32_bf16 v[64:67], v[160:163], a[28:31], v[64:67]
    ds_read_b64_tr_b16 a[92:93], v2 offset:25344
    ds_read_b64_tr_b16 a[94:95], v2 offset:29568
    v_mfma_f32_16x16x32_bf16 v[32:35], v[152:155], a[28:31], v[32:35]
    ds_read_b64_tr_b16 a[100:101], v2 offset:25376
    ds_read_b64_tr_b16 a[102:103], v2 offset:29600
    v_mfma_f32_16x16x32_bf16 v[32:35], v[148:151], a[24:27], v[32:35]
    ds_read_b64_tr_b16 a[96:97], v2 offset:16928
    ds_read_b64_tr_b16 a[98:99], v2 offset:21152
    v_mfma_f32_16x16x32_bf16 a[68:71], a[64:67], v[172:175], a[68:71]
    ds_read_b64_tr_b16 a[104:105], v2 offset:17152
    ds_read_b64_tr_b16 a[106:107], v2 offset:21376
    v_mfma_f32_16x16x32_bf16 a[68:71], a[64:67], v[176:179], a[68:71]
    ds_read_b64_tr_b16 a[108:109], v2 offset:25600
    ds_read_b64_tr_b16 a[110:111], v2 offset:29824
    v_mfma_f32_16x16x32_bf16 a[72:75], a[64:67], v[180:183], a[72:75]
    ds_read_b64_tr_b16 a[116:117], v2 offset:25632
    ds_read_b64_tr_b16 a[118:119], v2 offset:29856
    v_mfma_f32_16x16x32_bf16 a[72:75], a[64:67], v[184:187], a[72:75]
    s_waitcnt lgkmcnt(12)
    ds_read_b64_tr_b16 a[112:113], v2 offset:17184
    ds_read_b64_tr_b16 a[114:115], v2 offset:21408
    v_mfma_f32_16x16x32_bf16 a[76:79], a[64:67], v[188:191], a[76:79]
    s_waitcnt lgkmcnt(12)
    ds_read_b64_tr_b16 a[120:121], v2 offset:17408
    ds_read_b64_tr_b16 a[122:123], v2 offset:21632
    v_mfma_f32_16x16x32_bf16 a[76:79], a[64:67], v[192:195], a[76:79]
    s_waitcnt lgkmcnt(12)
    ds_read_b64_tr_b16 a[124:125], v2 offset:25856
    ds_read_b64_tr_b16 a[126:127], v2 offset:30080
    v_mfma_f32_16x16x32_bf16 v[4:7], v[172:175], a[88:91], v[4:7]
    s_waitcnt lgkmcnt(12)
    ds_read_b64_tr_b16 a[132:133], v2 offset:25888
    ds_read_b64_tr_b16 a[134:135], v2 offset:30112
    v_mfma_f32_16x16x32_bf16 v[4:7], v[176:179], a[92:95], v[4:7]
    s_waitcnt lgkmcnt(12)
    ds_read_b64_tr_b16 a[128:129], v2 offset:17440
    ds_read_b64_tr_b16 a[130:131], v2 offset:21664
    v_mfma_f32_16x16x32_bf16 v[8:11], v[176:179], a[100:103], v[8:11]
    s_waitcnt lgkmcnt(12)
    ds_read_b64_tr_b16 a[136:137], v2 offset:17664
    ds_read_b64_tr_b16 a[138:139], v2 offset:21888
    v_mfma_f32_16x16x32_bf16 v[8:11], v[172:175], a[96:99], v[8:11]
    s_waitcnt lgkmcnt(12)
    ds_read_b64_tr_b16 a[140:141], v2 offset:26112
    ds_read_b64_tr_b16 a[142:143], v2 offset:30336
    v_mfma_f32_16x16x32_bf16 v[12:15], v[172:175], a[104:107], v[12:15]
    s_waitcnt lgkmcnt(12)
    ds_read_b64_tr_b16 a[148:149], v2 offset:26144
    ds_read_b64_tr_b16 a[150:151], v2 offset:30368
    v_mfma_f32_16x16x32_bf16 v[12:15], v[176:179], a[108:111], v[12:15]
    s_waitcnt lgkmcnt(12)
    ds_read_b64_tr_b16 a[144:145], v2 offset:17696
    ds_read_b64_tr_b16 a[146:147], v2 offset:21920
    v_mfma_f32_16x16x32_bf16 v[16:19], v[176:179], a[116:119], v[16:19]
    s_waitcnt lgkmcnt(12)
    v_accvgpr_read_b32 v100, a68
    v_accvgpr_read_b32 v101, a72
    v_mfma_f32_16x16x32_bf16 v[16:19], v[172:175], a[112:115], v[16:19]
    s_waitcnt lgkmcnt(12)
    v_accvgpr_read_b32 v102, a76
    v_add_f32 v103, v100, v101
    v_mfma_f32_16x16x32_bf16 v[20:23], v[172:175], a[120:123], v[20:23]
    s_waitcnt lgkmcnt(12)
    v_add_f32 v103, v103, v102
    v_cmp_ngt_f32 vcc, s36, v103
    v_mfma_f32_16x16x32_bf16 v[20:23], v[176:179], a[124:127], v[20:23]
    s_waitcnt lgkmcnt(10)
    v_rcp_f32 v100, v100
    v_mfma_f32_16x16x32_bf16 v[24:27], v[176:179], a[132:135], v[24:27]
    s_waitcnt lgkmcnt(8)
    v_rcp_f32 v101, v101
    v_mfma_f32_16x16x32_bf16 v[24:27], v[172:175], a[128:131], v[24:27]
    s_waitcnt lgkmcnt(6)
    v_rcp_f32 v102, v102
    v_mfma_f32_16x16x32_bf16 v[28:31], v[172:175], a[136:139], v[28:31]
    s_waitcnt lgkmcnt(0)
    ds_write_b32 v200, v100 offset:15360
    ds_write_b32 v200, v101 offset:15424
    ds_write_b32 v200, v102 offset:15488
    v_mfma_f32_16x16x32_bf16 v[28:31], v[176:179], a[140:143], v[28:31]
    ds_read_b128 v[104:107], v201 offset:15360
    ds_read_b128 v[108:111], v201 offset:15424
    ds_read_b128 v[112:115], v201 offset:15488
    v_mfma_f32_16x16x32_bf16 v[32:35], v[176:179], a[148:151], v[32:35]
    s_cbranch_vccnz L_slow
    v_mfma_f32_16x16x32_bf16 v[32:35], v[172:175], a[144:147], v[32:35]
    v_mfma_f32_16x16x32_bf16 v[64:67], v[180:183], a[144:147], v[64:67]
    v_mfma_f32_16x16x32_bf16 v[64:67], v[184:187], a[148:151], v[64:67]
    v_mfma_f32_16x16x32_bf16 v[60:63], v[184:187], a[140:143], v[60:63]
    s_waitcnt lgkmcnt(0)
    v_mul_f32 v4, v4, v104
    v_mul_f32 v8, v8, v104
    v_mul_f32 v12, v12, v104
    v_mfma_f32_16x16x32_bf16 v[60:63], v[180:183], a[136:139], v[60:63]
    v_mul_f32 v16, v16, v104
    v_mul_f32 v20, v20, v104
    v_mul_f32 v24, v24, v104
    v_mfma_f32_16x16x32_bf16 v[56:59], v[180:183], a[128:131], v[56:59]
    v_mul_f32 v28, v28, v104
    v_mul_f32 v32, v32, v104
    v_cvt_pk_bf16_f32 v116, v4, v8
    v_mfma_f32_16x16x32_bf16 v[56:59], v[184:187], a[132:135], v[56:59]
    v_cvt_pk_bf16_f32 v117, v12, v16
    v_cvt_pk_bf16_f32 v118, v20, v24
    v_cvt_pk_bf16_f32 v119, v28, v32
    v_mfma_f32_16x16x32_bf16 v[52:55], v[184:187], a[124:127], v[52:55]
    ds_write_b128 v197, v[116:119] offset:0
    ds_read_b64_tr_b16 v[148:149], v198 offset:0
    ds_read_b64_tr_b16 v[150:151], v198 offset:64
    v_mul_f32 v5, v5, v105
    v_mul_f32 v9, v9, v105
    v_mul_f32 v13, v13, v105
    v_mfma_f32_16x16x32_bf16 v[52:55], v[180:183], a[120:123], v[52:55]
    v_mul_f32 v17, v17, v105
    v_mul_f32 v21, v21, v105
    v_mul_f32 v25, v25, v105
    v_mfma_f32_16x16x32_bf16 v[48:51], v[180:183], a[112:115], v[48:51]
    v_mul_f32 v29, v29, v105
    v_mul_f32 v33, v33, v105
    v_cvt_pk_bf16_f32 v120, v5, v9
    v_mfma_f32_16x16x32_bf16 v[48:51], v[184:187], a[116:119], v[48:51]
    v_cvt_pk_bf16_f32 v121, v13, v17
    v_cvt_pk_bf16_f32 v122, v21, v25
    v_cvt_pk_bf16_f32 v123, v29, v33
    v_mfma_f32_16x16x32_bf16 v[44:47], v[184:187], a[108:111], v[44:47]
    ds_write_b128 v197, v[120:123] offset:1280
    ds_read_b64_tr_b16 v[152:153], v198 offset:1280
    ds_read_b64_tr_b16 v[154:155], v198 offset:1344
    v_mul_f32 v6, v6, v106
    v_mul_f32 v10, v10, v106
    v_mul_f32 v14, v14, v106
    v_mul_f32 v18, v18, v106
    v_mfma_f32_16x16x32_bf16 v[44:47], v[180:183], a[104:107], v[44:47]
    s_waitcnt lgkmcnt(3)
    buffer_store_dwordx4 v[148:151], v199, s[24:27], s37 offen nt
    v_mul_f32 v22, v22, v106
    v_mul_f32 v26, v26, v106
    v_mul_f32 v30, v30, v106
    v_mul_f32 v34, v34, v106
    v_mfma_f32_16x16x32_bf16 v[40:43], v[180:183], a[96:99], v[40:43]
    v_cvt_pk_bf16_f32 v124, v6, v10
    v_cvt_pk_bf16_f32 v125, v14, v18
    v_cvt_pk_bf16_f32 v126, v22, v26
    v_cvt_pk_bf16_f32 v127, v30, v34
    v_mfma_f32_16x16x32_bf16 v[40:43], v[184:187], a[100:103], v[40:43]
    ds_write_b128 v197, v[124:127] offset:2560
    ds_read_b64_tr_b16 v[156:157], v198 offset:2560
    ds_read_b64_tr_b16 v[158:159], v198 offset:2624
    v_mul_f32 v7, v7, v107
    v_mul_f32 v11, v11, v107
    v_mul_f32 v15, v15, v107
    v_mfma_f32_16x16x32_bf16 v[36:39], v[184:187], a[92:95], v[36:39]
    s_waitcnt lgkmcnt(3)
    buffer_store_dwordx4 v[152:155], v199, s[24:27], s37 offen offset:256 nt
    v_mul_f32 v19, v19, v107
    v_mul_f32 v23, v23, v107
    v_mul_f32 v27, v27, v107
    v_mfma_f32_16x16x32_bf16 v[36:39], v[180:183], a[88:91], v[36:39]
    v_mul_f32 v31, v31, v107
    v_mul_f32 v35, v35, v107
    v_cvt_pk_bf16_f32 v128, v7, v11
    v_mfma_f32_16x16x32_bf16 v[68:71], v[188:191], a[88:91], v[68:71]
    v_cvt_pk_bf16_f32 v129, v15, v19
    v_cvt_pk_bf16_f32 v130, v23, v27
    v_cvt_pk_bf16_f32 v131, v31, v35
    v_mfma_f32_16x16x32_bf16 v[68:71], v[192:195], a[92:95], v[68:71]
    ds_write_b128 v197, v[128:131] offset:3840
    ds_read_b64_tr_b16 v[160:161], v198 offset:3840
    ds_read_b64_tr_b16 v[162:163], v198 offset:3904
    v_mul_f32 v64, v64, v108
    v_mul_f32 v60, v60, v108
    v_mul_f32 v56, v56, v108
    v_mfma_f32_16x16x32_bf16 v[72:75], v[192:195], a[100:103], v[72:75]
    s_waitcnt lgkmcnt(3)
    buffer_store_dwordx4 v[156:159], v199, s[24:27], s37 offen offset:512 nt
    v_mul_f32 v52, v52, v108
    v_mul_f32 v48, v48, v108
    v_mul_f32 v44, v44, v108
    v_mfma_f32_16x16x32_bf16 v[72:75], v[188:191], a[96:99], v[72:75]
    v_mul_f32 v40, v40, v108
    v_mul_f32 v36, v36, v108
    v_cvt_pk_bf16_f32 v132, v36, v40
    v_mfma_f32_16x16x32_bf16 v[76:79], v[188:191], a[104:107], v[76:79]
    v_cvt_pk_bf16_f32 v133, v44, v48
    v_cvt_pk_bf16_f32 v134, v52, v56
    v_cvt_pk_bf16_f32 v135, v60, v64
    v_mfma_f32_16x16x32_bf16 v[76:79], v[192:195], a[108:111], v[76:79]
    ds_write_b128 v197, v[132:135] offset:5120
    ds_read_b64_tr_b16 v[224:225], v198 offset:5120
    ds_read_b64_tr_b16 v[226:227], v198 offset:5184
    v_mul_f32 v65, v65, v109
    v_mul_f32 v61, v61, v109
    v_mul_f32 v57, v57, v109
    v_mul_f32 v53, v53, v109
    v_mfma_f32_16x16x32_bf16 v[80:83], v[192:195], a[116:119], v[80:83]
    s_waitcnt lgkmcnt(3)
    buffer_store_dwordx4 v[160:163], v199, s[24:27], s37 offen offset:768 nt
    v_mul_f32 v49, v49, v109
    v_mul_f32 v45, v45, v109
    v_mul_f32 v41, v41, v109
    v_mul_f32 v37, v37, v109
    v_mfma_f32_16x16x32_bf16 v[80:83], v[188:191], a[112:115], v[80:83]
    v_cvt_pk_bf16_f32 v136, v37, v41
    v_cvt_pk_bf16_f32 v137, v45, v49
    v_cvt_pk_bf16_f32 v138, v53, v57
    v_cvt_pk_bf16_f32 v139, v61, v65
    v_mfma_f32_16x16x32_bf16 v[84:87], v[188:191], a[120:123], v[84:87]
    ds_write_b128 v197, v[136:139] offset:6400
    ds_read_b64_tr_b16 v[228:229], v198 offset:6400
    ds_read_b64_tr_b16 v[230:231], v198 offset:6464
    v_mul_f32 v66, v66, v110
    v_mul_f32 v62, v62, v110
    v_mul_f32 v58, v58, v110
    v_mfma_f32_16x16x32_bf16 v[84:87], v[192:195], a[124:127], v[84:87]
    s_waitcnt lgkmcnt(3)
    buffer_store_dwordx4 v[224:227], v199, s[24:27], s38 offen nt
    v_mul_f32 v54, v54, v110
    v_mul_f32 v50, v50, v110
    v_mul_f32 v46, v46, v110
    v_mfma_f32_16x16x32_bf16 v[88:91], v[192:195], a[132:135], v[88:91]
    v_mul_f32 v42, v42, v110
    v_mul_f32 v38, v38, v110
    v_cvt_pk_bf16_f32 v140, v38, v42
    v_mfma_f32_16x16x32_bf16 v[88:91], v[188:191], a[128:131], v[88:91]
    v_cvt_pk_bf16_f32 v141, v46, v50
    v_cvt_pk_bf16_f32 v142, v54, v58
    v_cvt_pk_bf16_f32 v143, v62, v66
    v_mfma_f32_16x16x32_bf16 v[92:95], v[188:191], a[136:139], v[92:95]
    ds_write_b128 v197, v[140:143] offset:7680
    ds_read_b64_tr_b16 v[232:233], v198 offset:7680
    ds_read_b64_tr_b16 v[234:235], v198 offset:7744
    v_mul_f32 v67, v67, v111
    v_mul_f32 v63, v63, v111
    v_mul_f32 v59, v59, v111
    v_mfma_f32_16x16x32_bf16 v[92:95], v[192:195], a[140:143], v[92:95]
    s_waitcnt lgkmcnt(3)
    buffer_store_dwordx4 v[228:231], v199, s[24:27], s38 offen offset:256 nt
    v_mul_f32 v55, v55, v111
    v_mul_f32 v51, v51, v111
    v_mul_f32 v47, v47, v111
    v_mfma_f32_16x16x32_bf16 v[96:99], v[192:195], a[148:151], v[96:99]
    v_mul_f32 v43, v43, v111
    v_mul_f32 v39, v39, v111
    v_cvt_pk_bf16_f32 v144, v39, v43
    v_mfma_f32_16x16x32_bf16 v[96:99], v[188:191], a[144:147], v[96:99]
    v_cvt_pk_bf16_f32 v145, v47, v51
    v_cvt_pk_bf16_f32 v146, v55, v59
    v_cvt_pk_bf16_f32 v147, v63, v67
    ds_write_b128 v197, v[144:147] offset:8960
    ds_read_b64_tr_b16 v[236:237], v198 offset:8960
    ds_read_b64_tr_b16 v[238:239], v198 offset:9024
    s_waitcnt lgkmcnt(3)
    buffer_store_dwordx4 v[232:235], v199, s[24:27], s38 offen offset:512 nt
    v_pk_mul_f32 v[68:69], v[68:69], v[112:113]
    v_pk_mul_f32 v[72:73], v[72:73], v[112:113]
    v_pk_mul_f32 v[76:77], v[76:77], v[112:113]
    v_pk_mul_f32 v[80:81], v[80:81], v[112:113]
    v_pk_mul_f32 v[84:85], v[84:85], v[112:113]
    v_pk_mul_f32 v[88:89], v[88:89], v[112:113]
    v_pk_mul_f32 v[92:93], v[92:93], v[112:113]
    v_pk_mul_f32 v[96:97], v[96:97], v[112:113]
    v_cvt_pk_bf16_f32 v116, v68, v72
    v_cvt_pk_bf16_f32 v117, v76, v80
    v_cvt_pk_bf16_f32 v118, v84, v88
    v_cvt_pk_bf16_f32 v119, v92, v96
    s_waitcnt lgkmcnt(0)
    buffer_store_dwordx4 v[236:239], v199, s[24:27], s38 offen offset:768 nt
    ds_write_b128 v197, v[116:119] offset:10240
    ds_read_b64_tr_b16 v[240:241], v198 offset:10240
    ds_read_b64_tr_b16 v[242:243], v198 offset:10304
    v_cvt_pk_bf16_f32 v120, v69, v73
    v_cvt_pk_bf16_f32 v121, v77, v81
    v_cvt_pk_bf16_f32 v122, v85, v89
    v_cvt_pk_bf16_f32 v123, v93, v97
    ds_write_b128 v197, v[120:123] offset:11520
    ds_read_b64_tr_b16 v[244:245], v198 offset:11520
    ds_read_b64_tr_b16 v[246:247], v198 offset:11584
    v_pk_mul_f32 v[70:71], v[70:71], v[114:115]
    v_pk_mul_f32 v[74:75], v[74:75], v[114:115]
    v_pk_mul_f32 v[78:79], v[78:79], v[114:115]
    v_pk_mul_f32 v[82:83], v[82:83], v[114:115]
    v_pk_mul_f32 v[86:87], v[86:87], v[114:115]
    v_pk_mul_f32 v[90:91], v[90:91], v[114:115]
    v_pk_mul_f32 v[94:95], v[94:95], v[114:115]
    v_pk_mul_f32 v[98:99], v[98:99], v[114:115]
    v_cvt_pk_bf16_f32 v124, v70, v74
    v_cvt_pk_bf16_f32 v125, v78, v82
    v_cvt_pk_bf16_f32 v126, v86, v90
    v_cvt_pk_bf16_f32 v127, v94, v98
    s_waitcnt lgkmcnt(3)
    buffer_store_dwordx4 v[240:243], v199, s[24:27], s39 offen nt
    ds_write_b128 v197, v[124:127] offset:12800
    ds_read_b64_tr_b16 v[248:249], v198 offset:12800
    ds_read_b64_tr_b16 v[250:251], v198 offset:12864
    v_cvt_pk_bf16_f32 v128, v71, v75
    v_cvt_pk_bf16_f32 v129, v79, v83
    v_cvt_pk_bf16_f32 v130, v87, v91
    v_cvt_pk_bf16_f32 v131, v95, v99
    s_waitcnt lgkmcnt(3)
    buffer_store_dwordx4 v[244:247], v199, s[24:27], s39 offen offset:256 nt
    ds_write_b128 v197, v[128:131] offset:14080
    ds_read_b64_tr_b16 v[252:253], v198 offset:14080
    ds_read_b64_tr_b16 v[254:255], v198 offset:14144
    s_waitcnt lgkmcnt(3)
    buffer_store_dwordx4 v[248:251], v199, s[24:27], s39 offen offset:512 nt
    s_waitcnt lgkmcnt(0)
    buffer_store_dwordx4 v[252:255], v199, s[24:27], s39 offen offset:768 nt
L_fin:
L_end:
    s_endpgm
L_slow:
    s_waitcnt vmcnt(0) lgkmcnt(0)
    s_nop 7
    v_accvgpr_read_b32 v0, a85
    v_add_u32 v1, s29, v1
    s_sub_u32 s38, s29, 67584
    v_add_u32 v2, s38, v2
    v_mov_b64 v[4:5], 0
    v_mov_b64 v[6:7], 0
    v_mov_b64 v[8:9], 0
    v_mov_b64 v[10:11], 0
    v_mov_b64 v[12:13], 0
    v_mov_b64 v[14:15], 0
    v_mov_b64 v[16:17], 0
    v_mov_b64 v[18:19], 0
    v_mov_b64 v[20:21], 0
    v_mov_b64 v[22:23], 0
    v_mov_b64 v[24:25], 0
    v_mov_b64 v[26:27], 0
    v_mov_b64 v[28:29], 0
    v_mov_b64 v[30:31], 0
    v_mov_b64 v[32:33], 0
    v_mov_b64 v[34:35], 0
    v_mov_b64 v[36:37], 0
    v_mov_b64 v[38:39], 0
    v_mov_b64 v[40:41], 0
    v_mov_b64 v[42:43], 0
    v_mov_b64 v[44:45], 0
    v_mov_b64 v[46:47], 0
    v_mov_b64 v[48:49], 0
    v_mov_b64 v[50:51], 0
    v_mov_b64 v[52:53], 0
    v_mov_b64 v[54:55], 0
    v_mov_b64 v[56:57], 0
    v_mov_b64 v[58:59], 0
    v_mov_b64 v[60:61], 0
    v_mov_b64 v[62:63], 0
    v_mov_b64 v[64:65], 0
    v_mov_b64 v[66:67], 0
    v_mov_b64 v[68:69], 0
    v_mov_b64 v[70:71], 0
    v_mov_b64 v[72:73], 0
    v_mov_b64 v[74:75], 0
    v_mov_b64 v[76:77], 0
    v_mov_b64 v[78:79], 0
    v_mov_b64 v[80:81], 0
    v_mov_b64 v[82:83], 0
    v_mov_b64 v[84:85], 0
    v_mov_b64 v[86:87], 0
    v_mov_b64 v[88:89], 0
    v_mov_b64 v[90:91], 0
    v_mov_b64 v[92:93], 0
    v_mov_b64 v[94:95], 0
    v_mov_b64 v[96:97], 0
    v_mov_b64 v[98:99], 0
    v_accvgpr_write_b32 a68, 0
    v_accvgpr_write_b32 a69, 0
    v_accvgpr_write_b32 a70, 0
    v_accvgpr_write_b32 a71, 0
    v_accvgpr_write_b32 a72, 0
    v_accvgpr_write_b32 a73, 0
    v_accvgpr_write_b32 a74, 0
    v_accvgpr_write_b32 a75, 0
    v_accvgpr_write_b32 a76, 0
    v_accvgpr_write_b32 a77, 0
    v_accvgpr_write_b32 a78, 0
    v_accvgpr_write_b32 a79, 0
    v_mov_b32 v172, 0xff7fffff
    v_mov_b32 v173, 0xff7fffff
    v_mov_b32 v174, 0xff7fffff
    s_mov_b32 s32, 0
L_slow_loop:
    s_add_u32 m0, s29, 0
    s_add_u32 s38, s32, 0
    buffer_load_dwordx4 v0, s[16:19], s38 offen lds
    s_add_u32 m0, s29, 1056
    s_add_u32 s38, s32, 1024
    buffer_load_dwordx4 v0, s[16:19], s38 offen lds
    s_add_u32 m0, s29, 2112
    s_add_u32 s38, s32, 2048
    buffer_load_dwordx4 v0, s[16:19], s38 offen lds
    s_add_u32 m0, s29, 3168
    s_add_u32 s38, s32, 3072
    buffer_load_dwordx4 v0, s[16:19], s38 offen lds
    s_add_u32 m0, s29, 4224
    s_add_u32 s38, s32, 4096
    buffer_load_dwordx4 v0, s[16:19], s38 offen lds
    s_add_u32 m0, s29, 5280
    s_add_u32 s38, s32, 5120
    buffer_load_dwordx4 v0, s[16:19], s38 offen lds
    s_add_u32 m0, s29, 6336
    s_add_u32 s38, s32, 6144
    buffer_load_dwordx4 v0, s[16:19], s38 offen lds
    s_add_u32 m0, s29, 7392
    s_add_u32 s38, s32, 7168
    buffer_load_dwordx4 v0, s[16:19], s38 offen lds
    s_waitcnt vmcnt(0)
    ds_read_b128 a[0:3], v1 offset:0
    ds_read_b128 a[4:7], v1 offset:256
    ds_read_b128 a[8:11], v1 offset:512
    ds_read_b128 a[12:15], v1 offset:768
    ds_read_b128 a[16:19], v1 offset:4224
    ds_read_b128 a[20:23], v1 offset:4480
    ds_read_b128 a[24:27], v1 offset:4736
    ds_read_b128 a[28:31], v1 offset:4992
    s_waitcnt lgkmcnt(0)
    s_add_u32 m0, s29, 0
    s_add_u32 s38, s32, 12288
    buffer_load_dwordx4 v0, s[20:23], s38 offen lds
    s_add_u32 m0, s29, 1056
    s_add_u32 s38, s32, 13312
    buffer_load_dwordx4 v0, s[20:23], s38 offen lds
    s_add_u32 m0, s29, 2112
    s_add_u32 s38, s32, 14336
    buffer_load_dwordx4 v0, s[20:23], s38 offen lds
    s_add_u32 m0, s29, 3168
    s_add_u32 s38, s32, 15360
    buffer_load_dwordx4 v0, s[20:23], s38 offen lds
    s_add_u32 m0, s29, 4224
    s_add_u32 s38, s32, 16384
    buffer_load_dwordx4 v0, s[20:23], s38 offen lds
    s_add_u32 m0, s29, 5280
    s_add_u32 s38, s32, 17408
    buffer_load_dwordx4 v0, s[20:23], s38 offen lds
    s_add_u32 m0, s29, 6336
    s_add_u32 s38, s32, 18432
    buffer_load_dwordx4 v0, s[20:23], s38 offen lds
    s_add_u32 m0, s29, 7392
    s_add_u32 s38, s32, 19456
    buffer_load_dwordx4 v0, s[20:23], s38 offen lds
    s_waitcnt vmcnt(0)
    ds_read_b64_tr_b16 a[32:33], v2 offset:0
    ds_read_b64_tr_b16 a[34:35], v2 offset:4224
    ds_read_b64_tr_b16 a[36:37], v2 offset:32
    ds_read_b64_tr_b16 a[38:39], v2 offset:4256
    ds_read_b64_tr_b16 a[40:41], v2 offset:256
    ds_read_b64_tr_b16 a[42:43], v2 offset:4480
    ds_read_b64_tr_b16 a[44:45], v2 offset:288
    ds_read_b64_tr_b16 a[46:47], v2 offset:4512
    s_waitcnt lgkmcnt(0)
    ds_read_b64_tr_b16 a[48:49], v2 offset:512
    ds_read_b64_tr_b16 a[50:51], v2 offset:4736
    ds_read_b64_tr_b16 a[52:53], v2 offset:544
    ds_read_b64_tr_b16 a[54:55], v2 offset:4768
    ds_read_b64_tr_b16 a[56:57], v2 offset:768
    ds_read_b64_tr_b16 a[58:59], v2 offset:4992
    ds_read_b64_tr_b16 a[60:61], v2 offset:800
    ds_read_b64_tr_b16 a[62:63], v2 offset:5024
    v_mfma_f32_16x16x32_bf16 v[100:103], a[0:3], v[208:211], 0
    v_mfma_f32_16x16x32_bf16 v[100:103], a[4:7], v[212:215], v[100:103]
    v_mfma_f32_16x16x32_bf16 v[100:103], a[8:11], v[216:219], v[100:103]
    v_mfma_f32_16x16x32_bf16 v[100:103], a[12:15], v[220:223], v[100:103]
    v_mfma_f32_16x16x32_bf16 v[104:107], a[0:3], v[224:227], 0
    v_mfma_f32_16x16x32_bf16 v[104:107], a[4:7], v[228:231], v[104:107]
    v_mfma_f32_16x16x32_bf16 v[104:107], a[8:11], v[232:235], v[104:107]
    v_mfma_f32_16x16x32_bf16 v[104:107], a[12:15], v[236:239], v[104:107]
    v_mfma_f32_16x16x32_bf16 v[108:111], a[0:3], v[240:243], 0
    v_mfma_f32_16x16x32_bf16 v[108:111], a[4:7], v[244:247], v[108:111]
    v_mfma_f32_16x16x32_bf16 v[108:111], a[8:11], v[248:251], v[108:111]
    v_mfma_f32_16x16x32_bf16 v[108:111], a[12:15], v[252:255], v[108:111]
    v_mfma_f32_16x16x32_bf16 v[112:115], a[16:19], v[208:211], 0
    v_mfma_f32_16x16x32_bf16 v[112:115], a[20:23], v[212:215], v[112:115]
    v_mfma_f32_16x16x32_bf16 v[112:115], a[24:27], v[216:219], v[112:115]
    v_mfma_f32_16x16x32_bf16 v[112:115], a[28:31], v[220:223], v[112:115]
    v_mfma_f32_16x16x32_bf16 v[116:119], a[16:19], v[224:227], 0
    v_mfma_f32_16x16x32_bf16 v[116:119], a[20:23], v[228:231], v[116:119]
    v_mfma_f32_16x16x32_bf16 v[116:119], a[24:27], v[232:235], v[116:119]
    v_mfma_f32_16x16x32_bf16 v[116:119], a[28:31], v[236:239], v[116:119]
    v_mfma_f32_16x16x32_bf16 v[120:123], a[16:19], v[240:243], 0
    v_mfma_f32_16x16x32_bf16 v[120:123], a[20:23], v[244:247], v[120:123]
    v_mfma_f32_16x16x32_bf16 v[120:123], a[24:27], v[248:251], v[120:123]
    v_mfma_f32_16x16x32_bf16 v[120:123], a[28:31], v[252:255], v[120:123]
    s_nop 7
    v_max3_f32 v124, v100, v101, v102
    v_max3_f32 v124, v124, v103, v112
    v_max3_f32 v124, v124, v113, v114
    v_max3_f32 v124, v124, v115, v172
    v_max3_f32 v125, v104, v105, v106
    v_max3_f32 v125, v125, v107, v116
    v_max3_f32 v125, v125, v117, v118
    v_max3_f32 v125, v125, v119, v173
    v_max3_f32 v126, v108, v109, v110
    v_max3_f32 v126, v126, v111, v120
    v_max3_f32 v126, v126, v121, v122
    v_max3_f32 v126, v126, v123, v174
    v_mov_b32 v128, v124
    v_mov_b32 v129, v125
    v_mov_b32 v130, v126
    s_nop 1
    v_permlane16_swap_b32 v124, v128
    v_permlane16_swap_b32 v125, v129
    v_permlane16_swap_b32 v126, v130
    v_max_f32 v124, v124, v128
    v_max_f32 v125, v125, v129
    v_max_f32 v126, v126, v130
    v_mov_b32 v128, v124
    v_mov_b32 v129, v125
    v_mov_b32 v130, v126
    s_nop 1
    v_permlane32_swap_b32 v124, v128
    v_permlane32_swap_b32 v125, v129
    v_permlane32_swap_b32 v126, v130
    v_max_f32 v124, v124, v128
    v_max_f32 v125, v125, v129
    v_max_f32 v126, v126, v130
    v_sub_f32 v176, v172, v124
    v_sub_f32 v177, v173, v125
    v_sub_f32 v178, v174, v126
    v_exp_f32 v176, v176
    v_exp_f32 v177, v177
    v_exp_f32 v178, v178
    v_mov_b32 v172, v124
    v_mov_b32 v173, v125
    v_mov_b32 v174, v126
    s_waitcnt lgkmcnt(0)
    ds_write_b32 v200, v176 offset:15360
    ds_write_b32 v200, v177 offset:15424
    ds_write_b32 v200, v178 offset:15488
    s_waitcnt lgkmcnt(0)
    ds_read_b128 v[180:183], v201 offset:15360
    ds_read_b128 v[184:187], v201 offset:15424
    ds_read_b128 v[188:191], v201 offset:15488
    v_accvgpr_read_b32 v132, a68
    v_mul_f32 v132, v132, v176
    v_accvgpr_write_b32 a68, v132
    v_accvgpr_read_b32 v132, a69
    v_mul_f32 v132, v132, v176
    v_accvgpr_write_b32 a69, v132
    v_accvgpr_read_b32 v132, a70
    v_mul_f32 v132, v132, v176
    v_accvgpr_write_b32 a70, v132
    v_accvgpr_read_b32 v132, a71
    v_mul_f32 v132, v132, v176
    v_accvgpr_write_b32 a71, v132
    v_accvgpr_read_b32 v132, a72
    v_mul_f32 v132, v132, v177
    v_accvgpr_write_b32 a72, v132
    v_accvgpr_read_b32 v132, a73
    v_mul_f32 v132, v132, v177
    v_accvgpr_write_b32 a73, v132
    v_accvgpr_read_b32 v132, a74
    v_mul_f32 v132, v132, v177
    v_accvgpr_write_b32 a74, v132
    v_accvgpr_read_b32 v132, a75
    v_mul_f32 v132, v132, v177
    v_accvgpr_write_b32 a75, v132
    v_accvgpr_read_b32 v132, a76
    v_mul_f32 v132, v132, v178
    v_accvgpr_write_b32 a76, v132
    v_accvgpr_read_b32 v132, a77
    v_mul_f32 v132, v132, v178
    v_accvgpr_write_b32 a77, v132
    v_accvgpr_read_b32 v132, a78
    v_mul_f32 v132, v132, v178
    v_accvgpr_write_b32 a78, v132
    v_accvgpr_read_b32 v132, a79
    v_mul_f32 v132, v132, v178
    v_accvgpr_write_b32 a79, v132
    v_sub_f32 v100, v100, v172
    v_sub_f32 v101, v101, v172
    v_sub_f32 v102, v102, v172
    v_sub_f32 v103, v103, v172
    v_sub_f32 v104, v104, v173
    v_sub_f32 v105, v105, v173
    v_sub_f32 v106, v106, v173
    v_sub_f32 v107, v107, v173
    v_sub_f32 v108, v108, v174
    v_sub_f32 v109, v109, v174
    v_sub_f32 v110, v110, v174
    v_sub_f32 v111, v111, v174
    v_sub_f32 v112, v112, v172
    v_sub_f32 v113, v113, v172
    v_sub_f32 v114, v114, v172
    v_sub_f32 v115, v115, v172
    v_sub_f32 v116, v116, v173
    v_sub_f32 v117, v117, v173
    v_sub_f32 v118, v118, v173
    v_sub_f32 v119, v119, v173
    v_sub_f32 v120, v120, v174
    v_sub_f32 v121, v121, v174
    v_sub_f32 v122, v122, v174
    v_sub_f32 v123, v123, v174
    v_exp_f32 v100, v100
    v_exp_f32 v101, v101
    v_exp_f32 v102, v102
    v_exp_f32 v103, v103
    v_exp_f32 v104, v104
    v_exp_f32 v105, v105
    v_exp_f32 v106, v106
    v_exp_f32 v107, v107
    v_exp_f32 v108, v108
    v_exp_f32 v109, v109
    v_exp_f32 v110, v110
    v_exp_f32 v111, v111
    v_exp_f32 v120, v120
    v_exp_f32 v121, v121
    v_exp_f32 v122, v122
    v_exp_f32 v123, v123
    v_exp_f32 v116, v116
    v_exp_f32 v117, v117
    v_exp_f32 v118, v118
    v_exp_f32 v119, v119
    v_exp_f32 v112, v112
    v_exp_f32 v113, v113
    v_exp_f32 v114, v114
    v_exp_f32 v115, v115
    s_waitcnt lgkmcnt(0)
    v_cvt_pk_bf16_f32 v148, v100, v101
    v_cvt_pk_bf16_f32 v149, v102, v103
    v_cvt_pk_bf16_f32 v156, v104, v105
    v_cvt_pk_bf16_f32 v157, v106, v107
    v_cvt_pk_bf16_f32 v164, v108, v109
    v_cvt_pk_bf16_f32 v165, v110, v111
    v_cvt_pk_bf16_f32 v166, v120, v121
    v_cvt_pk_bf16_f32 v167, v122, v123
    v_cvt_pk_bf16_f32 v158, v116, v117
    v_cvt_pk_bf16_f32 v159, v118, v119
    v_cvt_pk_bf16_f32 v150, v112, v113
    v_cvt_pk_bf16_f32 v151, v114, v115
    v_mul_f32 v4, v4, v180
    v_mul_f32 v5, v5, v181
    v_mul_f32 v6, v6, v182
    v_mul_f32 v7, v7, v183
    v_mul_f32 v8, v8, v180
    v_mul_f32 v9, v9, v181
    v_mul_f32 v10, v10, v182
    v_mul_f32 v11, v11, v183
    v_mul_f32 v12, v12, v180
    v_mul_f32 v13, v13, v181
    v_mul_f32 v14, v14, v182
    v_mul_f32 v15, v15, v183
    v_mul_f32 v16, v16, v180
    v_mul_f32 v17, v17, v181
    v_mul_f32 v18, v18, v182
    v_mul_f32 v19, v19, v183
    v_mul_f32 v20, v20, v180
    v_mul_f32 v21, v21, v181
    v_mul_f32 v22, v22, v182
    v_mul_f32 v23, v23, v183
    v_mul_f32 v24, v24, v180
    v_mul_f32 v25, v25, v181
    v_mul_f32 v26, v26, v182
    v_mul_f32 v27, v27, v183
    v_mul_f32 v28, v28, v180
    v_mul_f32 v29, v29, v181
    v_mul_f32 v30, v30, v182
    v_mul_f32 v31, v31, v183
    v_mul_f32 v32, v32, v180
    v_mul_f32 v33, v33, v181
    v_mul_f32 v34, v34, v182
    v_mul_f32 v35, v35, v183
    v_mul_f32 v36, v36, v184
    v_mul_f32 v37, v37, v185
    v_mul_f32 v38, v38, v186
    v_mul_f32 v39, v39, v187
    v_mul_f32 v40, v40, v184
    v_mul_f32 v41, v41, v185
    v_mul_f32 v42, v42, v186
    v_mul_f32 v43, v43, v187
    v_mul_f32 v44, v44, v184
    v_mul_f32 v45, v45, v185
    v_mul_f32 v46, v46, v186
    v_mul_f32 v47, v47, v187
    v_mul_f32 v48, v48, v184
    v_mul_f32 v49, v49, v185
    v_mul_f32 v50, v50, v186
    v_mul_f32 v51, v51, v187
    v_mul_f32 v52, v52, v184
    v_mul_f32 v53, v53, v185
    v_mul_f32 v54, v54, v186
    v_mul_f32 v55, v55, v187
    v_mul_f32 v56, v56, v184
    v_mul_f32 v57, v57, v185
    v_mul_f32 v58, v58, v186
    v_mul_f32 v59, v59, v187
    v_mul_f32 v60, v60, v184
    v_mul_f32 v61, v61, v185
    v_mul_f32 v62, v62, v186
    v_mul_f32 v63, v63, v187
    v_mul_f32 v64, v64, v184
    v_mul_f32 v65, v65, v185
    v_mul_f32 v66, v66, v186
    v_mul_f32 v67, v67, v187
    v_mul_f32 v68, v68, v188
    v_mul_f32 v69, v69, v189
    v_mul_f32 v70, v70, v190
    v_mul_f32 v71, v71, v191
    v_mul_f32 v72, v72, v188
    v_mul_f32 v73, v73, v189
    v_mul_f32 v74, v74, v190
    v_mul_f32 v75, v75, v191
    v_mul_f32 v76, v76, v188
    v_mul_f32 v77, v77, v189
    v_mul_f32 v78, v78, v190
    v_mul_f32 v79, v79, v191
    v_mul_f32 v80, v80, v188
    v_mul_f32 v81, v81, v189
    v_mul_f32 v82, v82, v190
    v_mul_f32 v83, v83, v191
    v_mul_f32 v84, v84, v188
    v_mul_f32 v85, v85, v189
    v_mul_f32 v86, v86, v190
    v_mul_f32 v87, v87, v191
    v_mul_f32 v88, v88, v188
    v_mul_f32 v89, v89, v189
    v_mul_f32 v90, v90, v190
    v_mul_f32 v91, v91, v191
    v_mul_f32 v92, v92, v188
    v_mul_f32 v93, v93, v189
    v_mul_f32 v94, v94, v190
    v_mul_f32 v95, v95, v191
    v_mul_f32 v96, v96, v188
    v_mul_f32 v97, v97, v189
    v_mul_f32 v98, v98, v190
    v_mul_f32 v99, v99, v191
    s_nop 1
    v_mfma_f32_16x16x32_bf16 a[68:71], a[64:67], v[148:151], a[68:71]
    v_mfma_f32_16x16x32_bf16 a[72:75], a[64:67], v[156:159], a[72:75]
    v_mfma_f32_16x16x32_bf16 a[76:79], a[64:67], v[164:167], a[76:79]
    v_mfma_f32_16x16x32_bf16 v[4:7], v[148:151], a[32:35], v[4:7]
    v_mfma_f32_16x16x32_bf16 v[36:39], v[156:159], a[32:35], v[36:39]
    v_mfma_f32_16x16x32_bf16 v[68:71], v[164:167], a[32:35], v[68:71]
    v_mfma_f32_16x16x32_bf16 v[8:11], v[148:151], a[36:39], v[8:11]
    v_mfma_f32_16x16x32_bf16 v[40:43], v[156:159], a[36:39], v[40:43]
    v_mfma_f32_16x16x32_bf16 v[72:75], v[164:167], a[36:39], v[72:75]
    v_mfma_f32_16x16x32_bf16 v[12:15], v[148:151], a[40:43], v[12:15]
    v_mfma_f32_16x16x32_bf16 v[44:47], v[156:159], a[40:43], v[44:47]
    v_mfma_f32_16x16x32_bf16 v[76:79], v[164:167], a[40:43], v[76:79]
    v_mfma_f32_16x16x32_bf16 v[16:19], v[148:151], a[44:47], v[16:19]
    v_mfma_f32_16x16x32_bf16 v[48:51], v[156:159], a[44:47], v[48:51]
    v_mfma_f32_16x16x32_bf16 v[80:83], v[164:167], a[44:47], v[80:83]
    v_mfma_f32_16x16x32_bf16 v[20:23], v[148:151], a[48:51], v[20:23]
    v_mfma_f32_16x16x32_bf16 v[52:55], v[156:159], a[48:51], v[52:55]
    v_mfma_f32_16x16x32_bf16 v[84:87], v[164:167], a[48:51], v[84:87]
    v_mfma_f32_16x16x32_bf16 v[24:27], v[148:151], a[52:55], v[24:27]
    v_mfma_f32_16x16x32_bf16 v[56:59], v[156:159], a[52:55], v[56:59]
    v_mfma_f32_16x16x32_bf16 v[88:91], v[164:167], a[52:55], v[88:91]
    v_mfma_f32_16x16x32_bf16 v[28:31], v[148:151], a[56:59], v[28:31]
    v_mfma_f32_16x16x32_bf16 v[60:63], v[156:159], a[56:59], v[60:63]
    v_mfma_f32_16x16x32_bf16 v[92:95], v[164:167], a[56:59], v[92:95]
    v_mfma_f32_16x16x32_bf16 v[32:35], v[148:151], a[60:63], v[32:35]
    v_mfma_f32_16x16x32_bf16 v[64:67], v[156:159], a[60:63], v[64:67]
    v_mfma_f32_16x16x32_bf16 v[96:99], v[164:167], a[60:63], v[96:99]
    s_add_u32 s32, s32, 8192
    s_cmp_lt_u32 s32, 262144
    s_cbranch_scc1 L_slow_loop
    s_nop 7
    v_accvgpr_read_b32 v100, a68
    v_accvgpr_read_b32 v101, a72
    v_accvgpr_read_b32 v102, a76
    v_rcp_f32 v100, v100
    v_rcp_f32 v101, v101
    v_rcp_f32 v102, v102
    s_nop 0
    ds_write_b32 v200, v100 offset:15360
    ds_write_b32 v200, v101 offset:15424
    ds_write_b32 v200, v102 offset:15488
    ds_read_b128 v[104:107], v201 offset:15360
    ds_read_b128 v[108:111], v201 offset:15424
    ds_read_b128 v[112:115], v201 offset:15488
    s_waitcnt lgkmcnt(0)
    s_add_u32 s38, s37, 4096
    s_add_u32 s39, s37, 8192
    v_pk_mul_f32 v[4:5], v[4:5], v[104:105]
    v_pk_mul_f32 v[8:9], v[8:9], v[104:105]
    v_pk_mul_f32 v[12:13], v[12:13], v[104:105]
    v_pk_mul_f32 v[16:17], v[16:17], v[104:105]
    v_pk_mul_f32 v[20:21], v[20:21], v[104:105]
    v_pk_mul_f32 v[24:25], v[24:25], v[104:105]
    v_pk_mul_f32 v[28:29], v[28:29], v[104:105]
    v_pk_mul_f32 v[32:33], v[32:33], v[104:105]
    v_pk_mul_f32 v[6:7], v[6:7], v[106:107]
    v_pk_mul_f32 v[10:11], v[10:11], v[106:107]
    v_pk_mul_f32 v[14:15], v[14:15], v[106:107]
    v_pk_mul_f32 v[18:19], v[18:19], v[106:107]
    v_pk_mul_f32 v[22:23], v[22:23], v[106:107]
    v_pk_mul_f32 v[26:27], v[26:27], v[106:107]
    v_pk_mul_f32 v[30:31], v[30:31], v[106:107]
    v_pk_mul_f32 v[34:35], v[34:35], v[106:107]
    v_cvt_pk_bf16_f32 v116, v4, v8
    v_cvt_pk_bf16_f32 v117, v12, v16
    v_cvt_pk_bf16_f32 v118, v20, v24
    v_cvt_pk_bf16_f32 v119, v28, v32
    ds_write_b128 v197, v[116:119] offset:0
    ds_read_b64_tr_b16 v[148:149], v198 offset:0
    ds_read_b64_tr_b16 v[150:151], v198 offset:64
    v_cvt_pk_bf16_f32 v120, v5, v9
    v_cvt_pk_bf16_f32 v121, v13, v17
    v_cvt_pk_bf16_f32 v122, v21, v25
    v_cvt_pk_bf16_f32 v123, v29, v33
    ds_write_b128 v197, v[120:123] offset:1280
    ds_read_b64_tr_b16 v[152:153], v198 offset:1280
    ds_read_b64_tr_b16 v[154:155], v198 offset:1344
    v_cvt_pk_bf16_f32 v124, v6, v10
    v_cvt_pk_bf16_f32 v125, v14, v18
    v_cvt_pk_bf16_f32 v126, v22, v26
    v_cvt_pk_bf16_f32 v127, v30, v34
    ds_write_b128 v197, v[124:127] offset:2560
    ds_read_b64_tr_b16 v[156:157], v198 offset:2560
    ds_read_b64_tr_b16 v[158:159], v198 offset:2624
    v_cvt_pk_bf16_f32 v128, v7, v11
    v_cvt_pk_bf16_f32 v129, v15, v19
    v_cvt_pk_bf16_f32 v130, v23, v27
    v_cvt_pk_bf16_f32 v131, v31, v35
    ds_write_b128 v197, v[128:131] offset:3840
    ds_read_b64_tr_b16 v[160:161], v198 offset:3840
    ds_read_b64_tr_b16 v[162:163], v198 offset:3904
    s_waitcnt lgkmcnt(0)
    buffer_store_dwordx4 v[148:151], v199, s[24:27], s37 offen nt
    buffer_store_dwordx4 v[152:155], v199, s[24:27], s37 offen offset:256 nt
    buffer_store_dwordx4 v[156:159], v199, s[24:27], s37 offen offset:512 nt
    buffer_store_dwordx4 v[160:163], v199, s[24:27], s37 offen offset:768 nt
    v_pk_mul_f32 v[36:37], v[36:37], v[108:109]
    v_pk_mul_f32 v[40:41], v[40:41], v[108:109]
    v_pk_mul_f32 v[44:45], v[44:45], v[108:109]
    v_pk_mul_f32 v[48:49], v[48:49], v[108:109]
    v_pk_mul_f32 v[52:53], v[52:53], v[108:109]
    v_pk_mul_f32 v[56:57], v[56:57], v[108:109]
    v_pk_mul_f32 v[60:61], v[60:61], v[108:109]
    v_pk_mul_f32 v[64:65], v[64:65], v[108:109]
    v_pk_mul_f32 v[38:39], v[38:39], v[110:111]
    v_pk_mul_f32 v[42:43], v[42:43], v[110:111]
    v_pk_mul_f32 v[46:47], v[46:47], v[110:111]
    v_pk_mul_f32 v[50:51], v[50:51], v[110:111]
    v_pk_mul_f32 v[54:55], v[54:55], v[110:111]
    v_pk_mul_f32 v[58:59], v[58:59], v[110:111]
    v_pk_mul_f32 v[62:63], v[62:63], v[110:111]
    v_pk_mul_f32 v[66:67], v[66:67], v[110:111]
    v_cvt_pk_bf16_f32 v132, v36, v40
    v_cvt_pk_bf16_f32 v133, v44, v48
    v_cvt_pk_bf16_f32 v134, v52, v56
    v_cvt_pk_bf16_f32 v135, v60, v64
    ds_write_b128 v197, v[132:135] offset:5120
    ds_read_b64_tr_b16 v[224:225], v198 offset:5120
    ds_read_b64_tr_b16 v[226:227], v198 offset:5184
    v_cvt_pk_bf16_f32 v136, v37, v41
    v_cvt_pk_bf16_f32 v137, v45, v49
    v_cvt_pk_bf16_f32 v138, v53, v57
    v_cvt_pk_bf16_f32 v139, v61, v65
    ds_write_b128 v197, v[136:139] offset:6400
    ds_read_b64_tr_b16 v[228:229], v198 offset:6400
    ds_read_b64_tr_b16 v[230:231], v198 offset:6464
    v_cvt_pk_bf16_f32 v140, v38, v42
    v_cvt_pk_bf16_f32 v141, v46, v50
    v_cvt_pk_bf16_f32 v142, v54, v58
    v_cvt_pk_bf16_f32 v143, v62, v66
    ds_write_b128 v197, v[140:143] offset:7680
    ds_read_b64_tr_b16 v[232:233], v198 offset:7680
    ds_read_b64_tr_b16 v[234:235], v198 offset:7744
    v_cvt_pk_bf16_f32 v144, v39, v43
    v_cvt_pk_bf16_f32 v145, v47, v51
    v_cvt_pk_bf16_f32 v146, v55, v59
    v_cvt_pk_bf16_f32 v147, v63, v67
    ds_write_b128 v197, v[144:147] offset:8960
    ds_read_b64_tr_b16 v[236:237], v198 offset:8960
    ds_read_b64_tr_b16 v[238:239], v198 offset:9024
    s_waitcnt lgkmcnt(0)
    buffer_store_dwordx4 v[224:227], v199, s[24:27], s38 offen nt
    buffer_store_dwordx4 v[228:231], v199, s[24:27], s38 offen offset:256 nt
    buffer_store_dwordx4 v[232:235], v199, s[24:27], s38 offen offset:512 nt
    buffer_store_dwordx4 v[236:239], v199, s[24:27], s38 offen offset:768 nt
    v_pk_mul_f32 v[68:69], v[68:69], v[112:113]
    v_pk_mul_f32 v[72:73], v[72:73], v[112:113]
    v_pk_mul_f32 v[76:77], v[76:77], v[112:113]
    v_pk_mul_f32 v[80:81], v[80:81], v[112:113]
    v_pk_mul_f32 v[84:85], v[84:85], v[112:113]
    v_pk_mul_f32 v[88:89], v[88:89], v[112:113]
    v_pk_mul_f32 v[92:93], v[92:93], v[112:113]
    v_pk_mul_f32 v[96:97], v[96:97], v[112:113]
    v_pk_mul_f32 v[70:71], v[70:71], v[114:115]
    v_pk_mul_f32 v[74:75], v[74:75], v[114:115]
    v_pk_mul_f32 v[78:79], v[78:79], v[114:115]
    v_pk_mul_f32 v[82:83], v[82:83], v[114:115]
    v_pk_mul_f32 v[86:87], v[86:87], v[114:115]
    v_pk_mul_f32 v[90:91], v[90:91], v[114:115]
    v_pk_mul_f32 v[94:95], v[94:95], v[114:115]
    v_pk_mul_f32 v[98:99], v[98:99], v[114:115]
    v_cvt_pk_bf16_f32 v116, v68, v72
    v_cvt_pk_bf16_f32 v117, v76, v80
    v_cvt_pk_bf16_f32 v118, v84, v88
    v_cvt_pk_bf16_f32 v119, v92, v96
    ds_write_b128 v197, v[116:119] offset:10240
    ds_read_b64_tr_b16 v[240:241], v198 offset:10240
    ds_read_b64_tr_b16 v[242:243], v198 offset:10304
    v_cvt_pk_bf16_f32 v120, v69, v73
    v_cvt_pk_bf16_f32 v121, v77, v81
    v_cvt_pk_bf16_f32 v122, v85, v89
    v_cvt_pk_bf16_f32 v123, v93, v97
    ds_write_b128 v197, v[120:123] offset:11520
    ds_read_b64_tr_b16 v[244:245], v198 offset:11520
    ds_read_b64_tr_b16 v[246:247], v198 offset:11584
    v_cvt_pk_bf16_f32 v124, v70, v74
    v_cvt_pk_bf16_f32 v125, v78, v82
    v_cvt_pk_bf16_f32 v126, v86, v90
    v_cvt_pk_bf16_f32 v127, v94, v98
    ds_write_b128 v197, v[124:127] offset:12800
    ds_read_b64_tr_b16 v[248:249], v198 offset:12800
    ds_read_b64_tr_b16 v[250:251], v198 offset:12864
    v_cvt_pk_bf16_f32 v128, v71, v75
    v_cvt_pk_bf16_f32 v129, v79, v83
    v_cvt_pk_bf16_f32 v130, v87, v91
    v_cvt_pk_bf16_f32 v131, v95, v99
    ds_write_b128 v197, v[128:131] offset:14080
    ds_read_b64_tr_b16 v[252:253], v198 offset:14080
    ds_read_b64_tr_b16 v[254:255], v198 offset:14144
    s_waitcnt lgkmcnt(0)
    buffer_store_dwordx4 v[240:243], v199, s[24:27], s39 offen nt
    buffer_store_dwordx4 v[244:247], v199, s[24:27], s39 offen offset:256 nt
    buffer_store_dwordx4 v[248:251], v199, s[24:27], s39 offen offset:512 nt
    buffer_store_dwordx4 v[252:255], v199, s[24:27], s39 offen offset:768 nt
    s_branch L_fin
.section .rodata,"a"
.p2align 6
.amdhsa_kernel standalone__mha_softmax__near_ridge_kernel
  .amdhsa_next_free_vgpr 408
  .amdhsa_next_free_sgpr 102
  .amdhsa_accum_offset 256
  .amdhsa_group_segment_fixed_size 0
  .amdhsa_kernarg_size 48
  .amdhsa_user_sgpr_count 2
  .amdhsa_user_sgpr_kernarg_segment_ptr 1
  .amdhsa_system_sgpr_workgroup_id_x 1
  .amdhsa_float_denorm_mode_32 3
.end_amdhsa_kernel
```
